```python
import torch

def _softmax(x, axis=-1):
    return torch.softmax(x, dim=axis)
def _gelu(x):
    return torch.nn.functional.gelu(x, approximate="tanh")
def _silu(x):
    return torch.nn.functional.silu(x)
def _sigmoid(x):
    return torch.sigmoid(x)
def _layernorm(x, axis=-1, eps=1e-5):
    m = x.mean(dim=axis, keepdim=True)
    v = x.var(dim=axis, keepdim=True, unbiased=False)
    return (x - m) / torch.sqrt(v + eps)
def _scatter_add(tgt, idx, src, axis=0):
    return tgt.clone().index_add_(axis, idx, src)
def _segment_sum(src, seg, n):
    out = torch.zeros((n,) + src.shape[1:], dtype=src.dtype)
    return out.index_add_(0, seg, src)
def _pad(x, pw):
    flat = tuple(v for pair in reversed(pw) for v in pair)
    return torch.nn.functional.pad(x, flat)

kernel_name = 'parallel_sum__ssm_conv_h3__swiglu_ffn__prompt'

def setup_inputs():

    _w = (lambda a: (lambda t: t.to(torch.bfloat16) if t.is_floating_point() else t)(torch.as_tensor(a)))
    def _A_setup():
        B, S, D = 1, 2048, 512
        ks = 4
        return {
            "q": _w((lambda *s: torch.randn(*s, dtype=torch.bfloat16) * 0.05)(B, S, D)),
            "k": _w((lambda *s: torch.randn(*s, dtype=torch.bfloat16) * 0.4)(B, S, D)),
            "v": _w((lambda *s: torch.randn(*s, dtype=torch.bfloat16) * 0.4)(B, S, D)),
            "shift_k": _w((lambda *s: torch.randn(*s, dtype=torch.bfloat16) * 0.4)(D, ks) * 0.5),
            "ssm_k": _w((lambda *s: torch.randn(*s, dtype=torch.bfloat16) * 1.6)(D, S) * (1.0 / S ** 0.5)),
            "ssm_D": _w((lambda *s: torch.randn(*s, dtype=torch.bfloat16) * 0.8)(D)),
        }
    _A_in = _A_setup()

    def _B_setup():
        B, S, D, F = 1, 2048, 512, 1376
        return {
            "x": _w((lambda *s: torch.randn(*s, dtype=torch.bfloat16) * 0.05)(B, S, D)),
            "w_gate": _w((lambda *s: torch.randn(*s, dtype=torch.bfloat16) * 0.05)(D, F)),
            "w_up": _w((lambda *s: torch.randn(*s, dtype=torch.bfloat16) * 0.05)(D, F)),
            "w_down": _w((lambda *s: torch.randn(*s, dtype=torch.bfloat16) * 0.05)(F, D)),
        }
    _B_in = _B_setup()

    return {
        "A_q": _A_in["q"],
        "A_k": _A_in["k"],
        "A_v": _A_in["v"],
        "A_shift_k": _A_in["shift_k"],
        "A_ssm_k": _A_in["ssm_k"],
        "A_ssm_D": _A_in["ssm_D"],
        "B_x": _B_in["x"],
        "B_w_gate": _B_in["w_gate"],
        "B_w_up": _B_in["w_up"],
        "B_w_down": _B_in["w_down"],
    }

def reference(A_q, A_k, A_v, A_shift_k, A_ssm_k, A_ssm_D, B_x, B_w_gate, B_w_up, B_w_down):
    def _A_ref(q, k, v, shift_k, ssm_k, ssm_D):
        B, S, D = q.shape
        ks = shift_k.shape[-1]
        k_pad = _pad(k, ((0, 0), (ks - 1, 0), (0, 0)))
        k_shift = torch.zeros_like(k)
        for t in range(ks):
            k_shift = k_shift + k_pad[:, t:t + S, :] * shift_k[:, ks - 1 - t][None, None, :]
        kv = k_shift * v
        L = 2 * S
        kv_pad = _pad(kv, ((0, 0), (0, S), (0, 0)))
        kf_pad = _pad(ssm_k, ((0, 0), (0, S)))
        kv_f = (lambda x, axes=(-2,-1): torch.fft.rfft2(x.float(), dim=axes))(kv_pad[:, None, :, :], axes=(1, 2))
        kf_f = (lambda x, axes=(-2,-1): torch.fft.rfft2(x.float(), dim=axes))(kf_pad[:, None, :], axes=(1, 2))
        kf_f = (lambda x, *d: x.permute(*d))(kf_f, 1, 2, 0)
        y_f = kv_f * kf_f[None, :, :, :]
        y = (lambda x, s, axes=(-2,-1): torch.fft.irfft2(x, s=s, dim=axes).to(torch.bfloat16))(y_f, (1, L), axes=(1, 2))[:, 0, :S, :]
        y = y + kv * ssm_D[None, None, :]
        return q * y

    def _B_ref(x, w_gate, w_up, w_down):
        g = _silu(x @ w_gate)
        u = x @ w_up
        return (g * u) @ w_down

    x = A_q
    xn = _layernorm(x, axis=-1)
    return x + _A_ref(xn, A_k, A_v, A_shift_k, A_ssm_k, A_ssm_D) + _B_ref(xn, B_w_gate, B_w_up, B_w_down)
```

```asm
; @launch kernel=prep_kernel grid=(854,1,1) block=(256,1,1) lds=8192
; @launch kernel=mid_kernel grid=(752,1,1) block=(256,1,1) lds=61440
; @launch kernel=gemm2_kernel grid=(256,1,1) block=(256,1,1) lds=144384
.amdgcn_target "amdgcn-amd-amdhsa--gfx950"
.text
.globl prep_kernel
.p2align 8
.type prep_kernel,@function
prep_kernel:
  s_cmp_ge_u32 s2, 854
  s_cbranch_scc1 PREP_END
  s_load_dwordx2 s[40:41], s[0:1], 96
  s_cmp_ge_u32 s2, 512
  s_cbranch_scc1 PREP_NOT_LN
  s_load_dwordx2 s[42:43], s[0:1], 0
  v_lshrrev_b32 v1, 6, v0
  v_and_b32 v2, 63, v0
  s_lshl_b32 s3, s2, 2
  v_add_u32 v1, s3, v1
  v_lshlrev_b32 v1, 10, v1
  v_lshl_add_u32 v1, v2, 4, v1
  v_lshlrev_b32 v2, 2, v2
  v_xor_b32 v40, 4, v2
  v_xor_b32 v41, 8, v2
  v_xor_b32 v42, 16, v2
  v_xor_b32 v43, 32, v2
  v_xor_b32 v44, 64, v2
  v_xor_b32 v45, 128, v2
  s_waitcnt lgkmcnt(0)
  s_mov_b32 s8, s42
  s_mov_b32 s9, s43
  s_and_b32 s9, s9, 0xffff
  s_mov_b32 s10, 0x200000
  s_mov_b32 s11, 0x20000
  s_mov_b32 s12, s40
  s_mov_b32 s13, s41
  s_and_b32 s13, s13, 0xffff
  s_mov_b32 s14, 0x200000
  s_mov_b32 s15, 0x20000
  buffer_load_dwordx4 v[4:7], v1, s[8:11], 0 offen
  s_waitcnt vmcnt(0)
  v_lshlrev_b32 v8, 16, v4
  v_and_b32 v9, 0xffff0000, v4
  v_lshlrev_b32 v10, 16, v5
  v_and_b32 v11, 0xffff0000, v5
  v_lshlrev_b32 v12, 16, v6
  v_and_b32 v13, 0xffff0000, v6
  v_lshlrev_b32 v14, 16, v7
  v_and_b32 v15, 0xffff0000, v7
  v_add_f32 v16, v8, v9
  v_add_f32 v17, v10, v11
  v_add_f32 v18, v12, v13
  v_add_f32 v19, v14, v15
  v_add_f32 v16, v16, v17
  v_add_f32 v18, v18, v19
  v_add_f32 v16, v16, v18
  s_nop 1
  v_add_f32_dpp v16, v16, v16 quad_perm:[1,0,3,2] row_mask:0xf bank_mask:0xf
  s_nop 1
  v_add_f32_dpp v16, v16, v16 quad_perm:[2,3,0,1] row_mask:0xf bank_mask:0xf
  s_nop 1
  v_add_f32_dpp v16, v16, v16 row_half_mirror row_mask:0xf bank_mask:0xf
  s_nop 1
  v_add_f32_dpp v16, v16, v16 row_mirror row_mask:0xf bank_mask:0xf
  s_nop 0
  v_readlane_b32 s60, v16, 0
  v_readlane_b32 s61, v16, 16
  v_readlane_b32 s62, v16, 32
  v_readlane_b32 s63, v16, 48
  s_nop 1
  v_mov_b32 v16, s60
  v_add_f32 v16, s61, v16
  v_add_f32 v16, s62, v16
  v_add_f32 v16, s63, v16
  v_mul_f32 v16, 0x3b000000, v16
  v_sub_f32 v20, v8, v16
  v_sub_f32 v21, v9, v16
  v_sub_f32 v22, v10, v16
  v_sub_f32 v23, v11, v16
  v_sub_f32 v24, v12, v16
  v_sub_f32 v25, v13, v16
  v_sub_f32 v26, v14, v16
  v_sub_f32 v27, v15, v16
  v_mul_f32 v17, v20, v20
  v_fmac_f32 v17, v21, v21
  v_fmac_f32 v17, v22, v22
  v_fmac_f32 v17, v23, v23
  v_fmac_f32 v17, v24, v24
  v_fmac_f32 v17, v25, v25
  v_fmac_f32 v17, v26, v26
  v_fmac_f32 v17, v27, v27
  s_nop 1
  v_add_f32_dpp v17, v17, v17 quad_perm:[1,0,3,2] row_mask:0xf bank_mask:0xf
  s_nop 1
  v_add_f32_dpp v17, v17, v17 quad_perm:[2,3,0,1] row_mask:0xf bank_mask:0xf
  s_nop 1
  v_add_f32_dpp v17, v17, v17 row_half_mirror row_mask:0xf bank_mask:0xf
  s_nop 1
  v_add_f32_dpp v17, v17, v17 row_mirror row_mask:0xf bank_mask:0xf
  s_nop 0
  v_readlane_b32 s60, v17, 0
  v_readlane_b32 s61, v17, 16
  v_readlane_b32 s62, v17, 32
  v_readlane_b32 s63, v17, 48
  s_nop 1
  v_mov_b32 v17, s60
  v_add_f32 v17, s61, v17
  v_add_f32 v17, s62, v17
  v_add_f32 v17, s63, v17
  v_mul_f32 v17, 0x3b000000, v17
  v_cvt_pk_bf16_f32 v18, v16, v17
  v_lshlrev_b32 v16, 16, v18
  v_and_b32 v17, 0xffff0000, v18
  v_add_f32 v17, 0x3727c5ac, v17
  v_cvt_pk_bf16_f32 v18, v17, v17
  v_lshlrev_b32 v17, 16, v18
  v_sqrt_f32 v17, v17
  s_nop 0
  v_cvt_pk_bf16_f32 v18, v17, v17
  v_lshlrev_b32 v17, 16, v18
  v_rcp_f32 v19, v17
  v_sub_f32 v8, v8, v16
  v_sub_f32 v9, v9, v16
  v_sub_f32 v10, v10, v16
  v_sub_f32 v11, v11, v16
  v_sub_f32 v12, v12, v16
  v_sub_f32 v13, v13, v16
  v_sub_f32 v14, v14, v16
  v_sub_f32 v15, v15, v16
  v_cvt_pk_bf16_f32 v18, v8, v9
  v_lshlrev_b32 v8, 16, v18
  v_and_b32 v9, 0xffff0000, v18
  v_cvt_pk_bf16_f32 v18, v10, v11
  v_lshlrev_b32 v10, 16, v18
  v_and_b32 v11, 0xffff0000, v18
  v_cvt_pk_bf16_f32 v18, v12, v13
  v_lshlrev_b32 v12, 16, v18
  v_and_b32 v13, 0xffff0000, v18
  v_cvt_pk_bf16_f32 v18, v14, v15
  v_lshlrev_b32 v14, 16, v18
  v_and_b32 v15, 0xffff0000, v18
  v_mul_f32 v28, v8, v19
  v_fma_f32 v29, -v28, v17, v8
  v_fma_f32 v8, v29, v19, v28
  v_mul_f32 v28, v9, v19
  v_fma_f32 v29, -v28, v17, v9
  v_fma_f32 v9, v29, v19, v28
  v_mul_f32 v28, v10, v19
  v_fma_f32 v29, -v28, v17, v10
  v_fma_f32 v10, v29, v19, v28
  v_mul_f32 v28, v11, v19
  v_fma_f32 v29, -v28, v17, v11
  v_fma_f32 v11, v29, v19, v28
  v_mul_f32 v28, v12, v19
  v_fma_f32 v29, -v28, v17, v12
  v_fma_f32 v12, v29, v19, v28
  v_mul_f32 v28, v13, v19
  v_fma_f32 v29, -v28, v17, v13
  v_fma_f32 v13, v29, v19, v28
  v_mul_f32 v28, v14, v19
  v_fma_f32 v29, -v28, v17, v14
  v_fma_f32 v14, v29, v19, v28
  v_mul_f32 v28, v15, v19
  v_fma_f32 v29, -v28, v17, v15
  v_fma_f32 v15, v29, v19, v28
  v_cvt_pk_bf16_f32 v4, v8, v9
  v_cvt_pk_bf16_f32 v5, v10, v11
  v_cvt_pk_bf16_f32 v6, v12, v13
  v_cvt_pk_bf16_f32 v7, v14, v15
  v_lshrrev_b32 v30, 10, v1
  v_lshrrev_b32 v31, 4, v30
  v_lshlrev_b32 v31, 14, v31
  v_and_b32 v30, 15, v30
  v_lshl_add_u32 v31, v30, 4, v31
  v_and_b32 v30, 63, v0
  v_lshrrev_b32 v32, 2, v30
  v_lshl_add_u32 v31, v32, 10, v31
  v_and_b32 v30, 3, v30
  v_lshl_add_u32 v31, v30, 8, v31
  buffer_store_dwordx4 v[4:7], v31, s[12:15], 0 offen
  s_endpgm
PREP_NOT_LN:
  s_cmp_ge_u32 s2, 768
  s_cbranch_scc1 PREP_TR
  s_load_dwordx2 s[42:43], s[0:1], 8
  s_load_dwordx2 s[44:45], s[0:1], 16
  s_load_dwordx2 s[46:47], s[0:1], 24
  s_sub_u32 s3, s2, 512
  s_lshr_b32 s4, s3, 3
  s_and_b32 s5, s3, 7
  s_lshl_b32 s4, s4, 6
  s_lshl_b32 s5, s5, 6
  v_and_b32 v1, 7, v0
  v_lshrrev_b32 v2, 3, v0
  v_lshlrev_b32 v3, 3, v1
  v_add_u32 v3, s5, v3
  v_lshlrev_b32 v4, 3, v3
  v_add_u32 v5, s4, v2
  v_lshlrev_b32 v5, 10, v5
  v_lshl_add_u32 v5, v3, 1, v5
  s_waitcnt lgkmcnt(0)
  s_mov_b32 s8, s42
  s_mov_b32 s9, s43
  s_and_b32 s9, s9, 0xffff
  s_mov_b32 s10, 0x200000
  s_mov_b32 s11, 0x20000
  s_mov_b32 s12, s44
  s_mov_b32 s13, s45
  s_and_b32 s13, s13, 0xffff
  s_mov_b32 s14, 0x200000
  s_mov_b32 s15, 0x20000
  s_mov_b32 s16, s46
  s_mov_b32 s17, s47
  s_and_b32 s17, s17, 0xffff
  s_mov_b32 s18, 0x1000
  s_mov_b32 s19, 0x20000
  s_add_u32 s20, s40, 0x200000
  s_addc_u32 s21, s41, 0
  s_and_b32 s21, s21, 0xffff
  s_mov_b32 s22, 0x200000
  s_mov_b32 s23, 0x20000
  buffer_load_dwordx4 v[16:19], v4, s[16:19], 0 offen offset:0
  buffer_load_dwordx4 v[20:23], v4, s[16:19], 0 offen offset:16
  buffer_load_dwordx4 v[24:27], v4, s[16:19], 0 offen offset:32
  buffer_load_dwordx4 v[28:31], v4, s[16:19], 0 offen offset:48
  v_add_u32 v7, 0, v5
  buffer_load_dwordx4 v[32:35], v7, s[8:11], 0 offen
  v_add_u32 v8, 0xfffffc00, v7
  buffer_load_dwordx4 v[36:39], v8, s[8:11], 0 offen
  v_add_u32 v8, 0xfffff800, v7
  buffer_load_dwordx4 v[40:43], v8, s[8:11], 0 offen
  v_add_u32 v8, 0xfffff400, v7
  buffer_load_dwordx4 v[44:47], v8, s[8:11], 0 offen
  buffer_load_dwordx4 v[48:51], v7, s[12:15], 0 offen
  v_add_u32 v7, 32768, v5
  buffer_load_dwordx4 v[52:55], v7, s[8:11], 0 offen
  v_add_u32 v8, 0xfffffc00, v7
  buffer_load_dwordx4 v[56:59], v8, s[8:11], 0 offen
  v_add_u32 v8, 0xfffff800, v7
  buffer_load_dwordx4 v[60:63], v8, s[8:11], 0 offen
  v_add_u32 v8, 0xfffff400, v7
  buffer_load_dwordx4 v[64:67], v8, s[8:11], 0 offen
  buffer_load_dwordx4 v[68:71], v7, s[12:15], 0 offen
  v_xor_b32 v6, 7, v2
  v_lshlrev_b32 v6, 1, v6
  v_lshl_add_u32 v6, v1, 10, v6
  s_waitcnt vmcnt(10)
  s_waitcnt vmcnt(5)
  v_lshlrev_b32 v11, 16, v44
  v_and_b32 v12, 0xffff0000, v44
  v_and_b32 v13, 0xffff0000, v17
  v_mul_f32 v11, v11, v13
  v_and_b32 v13, 0xffff0000, v19
  v_mul_f32 v12, v12, v13
  v_cvt_pk_bf16_f32 v13, v11, v12
  v_lshlrev_b32 v11, 16, v13
  v_and_b32 v12, 0xffff0000, v13
  v_mov_b32 v9, v11
  v_mov_b32 v10, v12
  v_lshlrev_b32 v11, 16, v40
  v_and_b32 v12, 0xffff0000, v40
  v_lshlrev_b32 v13, 16, v17
  v_mul_f32 v11, v11, v13
  v_lshlrev_b32 v13, 16, v19
  v_mul_f32 v12, v12, v13
  v_cvt_pk_bf16_f32 v13, v11, v12
  v_lshlrev_b32 v11, 16, v13
  v_and_b32 v12, 0xffff0000, v13
  v_add_f32 v9, v9, v11
  v_add_f32 v10, v10, v12
  v_cvt_pk_bf16_f32 v13, v9, v10
  v_lshlrev_b32 v9, 16, v13
  v_and_b32 v10, 0xffff0000, v13
  v_lshlrev_b32 v11, 16, v36
  v_and_b32 v12, 0xffff0000, v36
  v_and_b32 v13, 0xffff0000, v16
  v_mul_f32 v11, v11, v13
  v_and_b32 v13, 0xffff0000, v18
  v_mul_f32 v12, v12, v13
  v_cvt_pk_bf16_f32 v13, v11, v12
  v_lshlrev_b32 v11, 16, v13
  v_and_b32 v12, 0xffff0000, v13
  v_add_f32 v9, v9, v11
  v_add_f32 v10, v10, v12
  v_cvt_pk_bf16_f32 v13, v9, v10
  v_lshlrev_b32 v9, 16, v13
  v_and_b32 v10, 0xffff0000, v13
  v_lshlrev_b32 v11, 16, v32
  v_and_b32 v12, 0xffff0000, v32
  v_lshlrev_b32 v13, 16, v16
  v_mul_f32 v11, v11, v13
  v_lshlrev_b32 v13, 16, v18
  v_mul_f32 v12, v12, v13
  v_cvt_pk_bf16_f32 v13, v11, v12
  v_lshlrev_b32 v11, 16, v13
  v_and_b32 v12, 0xffff0000, v13
  v_add_f32 v9, v9, v11
  v_add_f32 v10, v10, v12
  v_cvt_pk_bf16_f32 v13, v9, v10
  v_lshlrev_b32 v9, 16, v13
  v_and_b32 v10, 0xffff0000, v13
  v_lshlrev_b32 v11, 16, v48
  v_and_b32 v12, 0xffff0000, v48
  v_mul_f32 v9, v9, v11
  v_mul_f32 v10, v10, v12
  v_cvt_pk_bf16_f32 v13, v9, v10
  ds_write_b16 v6, v13 offset:0
  ds_write_b16_d16_hi v6, v13 offset:128
  v_lshlrev_b32 v11, 16, v45
  v_and_b32 v12, 0xffff0000, v45
  v_and_b32 v13, 0xffff0000, v21
  v_mul_f32 v11, v11, v13
  v_and_b32 v13, 0xffff0000, v23
  v_mul_f32 v12, v12, v13
  v_cvt_pk_bf16_f32 v13, v11, v12
  v_lshlrev_b32 v11, 16, v13
  v_and_b32 v12, 0xffff0000, v13
  v_mov_b32 v9, v11
  v_mov_b32 v10, v12
  v_lshlrev_b32 v11, 16, v41
  v_and_b32 v12, 0xffff0000, v41
  v_lshlrev_b32 v13, 16, v21
  v_mul_f32 v11, v11, v13
  v_lshlrev_b32 v13, 16, v23
  v_mul_f32 v12, v12, v13
  v_cvt_pk_bf16_f32 v13, v11, v12
  v_lshlrev_b32 v11, 16, v13
  v_and_b32 v12, 0xffff0000, v13
  v_add_f32 v9, v9, v11
  v_add_f32 v10, v10, v12
  v_cvt_pk_bf16_f32 v13, v9, v10
  v_lshlrev_b32 v9, 16, v13
  v_and_b32 v10, 0xffff0000, v13
  v_lshlrev_b32 v11, 16, v37
  v_and_b32 v12, 0xffff0000, v37
  v_and_b32 v13, 0xffff0000, v20
  v_mul_f32 v11, v11, v13
  v_and_b32 v13, 0xffff0000, v22
  v_mul_f32 v12, v12, v13
  v_cvt_pk_bf16_f32 v13, v11, v12
  v_lshlrev_b32 v11, 16, v13
  v_and_b32 v12, 0xffff0000, v13
  v_add_f32 v9, v9, v11
  v_add_f32 v10, v10, v12
  v_cvt_pk_bf16_f32 v13, v9, v10
  v_lshlrev_b32 v9, 16, v13
  v_and_b32 v10, 0xffff0000, v13
  v_lshlrev_b32 v11, 16, v33
  v_and_b32 v12, 0xffff0000, v33
  v_lshlrev_b32 v13, 16, v20
  v_mul_f32 v11, v11, v13
  v_lshlrev_b32 v13, 16, v22
  v_mul_f32 v12, v12, v13
  v_cvt_pk_bf16_f32 v13, v11, v12
  v_lshlrev_b32 v11, 16, v13
  v_and_b32 v12, 0xffff0000, v13
  v_add_f32 v9, v9, v11
  v_add_f32 v10, v10, v12
  v_cvt_pk_bf16_f32 v13, v9, v10
  v_lshlrev_b32 v9, 16, v13
  v_and_b32 v10, 0xffff0000, v13
  v_lshlrev_b32 v11, 16, v49
  v_and_b32 v12, 0xffff0000, v49
  v_mul_f32 v9, v9, v11
  v_mul_f32 v10, v10, v12
  v_cvt_pk_bf16_f32 v13, v9, v10
  ds_write_b16 v6, v13 offset:256
  ds_write_b16_d16_hi v6, v13 offset:384
  v_lshlrev_b32 v11, 16, v46
  v_and_b32 v12, 0xffff0000, v46
  v_and_b32 v13, 0xffff0000, v25
  v_mul_f32 v11, v11, v13
  v_and_b32 v13, 0xffff0000, v27
  v_mul_f32 v12, v12, v13
  v_cvt_pk_bf16_f32 v13, v11, v12
  v_lshlrev_b32 v11, 16, v13
  v_and_b32 v12, 0xffff0000, v13
  v_mov_b32 v9, v11
  v_mov_b32 v10, v12
  v_lshlrev_b32 v11, 16, v42
  v_and_b32 v12, 0xffff0000, v42
  v_lshlrev_b32 v13, 16, v25
  v_mul_f32 v11, v11, v13
  v_lshlrev_b32 v13, 16, v27
  v_mul_f32 v12, v12, v13
  v_cvt_pk_bf16_f32 v13, v11, v12
  v_lshlrev_b32 v11, 16, v13
  v_and_b32 v12, 0xffff0000, v13
  v_add_f32 v9, v9, v11
  v_add_f32 v10, v10, v12
  v_cvt_pk_bf16_f32 v13, v9, v10
  v_lshlrev_b32 v9, 16, v13
  v_and_b32 v10, 0xffff0000, v13
  v_lshlrev_b32 v11, 16, v38
  v_and_b32 v12, 0xffff0000, v38
  v_and_b32 v13, 0xffff0000, v24
  v_mul_f32 v11, v11, v13
  v_and_b32 v13, 0xffff0000, v26
  v_mul_f32 v12, v12, v13
  v_cvt_pk_bf16_f32 v13, v11, v12
  v_lshlrev_b32 v11, 16, v13
  v_and_b32 v12, 0xffff0000, v13
  v_add_f32 v9, v9, v11
  v_add_f32 v10, v10, v12
  v_cvt_pk_bf16_f32 v13, v9, v10
  v_lshlrev_b32 v9, 16, v13
  v_and_b32 v10, 0xffff0000, v13
  v_lshlrev_b32 v11, 16, v34
  v_and_b32 v12, 0xffff0000, v34
  v_lshlrev_b32 v13, 16, v24
  v_mul_f32 v11, v11, v13
  v_lshlrev_b32 v13, 16, v26
  v_mul_f32 v12, v12, v13
  v_cvt_pk_bf16_f32 v13, v11, v12
  v_lshlrev_b32 v11, 16, v13
  v_and_b32 v12, 0xffff0000, v13
  v_add_f32 v9, v9, v11
  v_add_f32 v10, v10, v12
  v_cvt_pk_bf16_f32 v13, v9, v10
  v_lshlrev_b32 v9, 16, v13
  v_and_b32 v10, 0xffff0000, v13
  v_lshlrev_b32 v11, 16, v50
  v_and_b32 v12, 0xffff0000, v50
  v_mul_f32 v9, v9, v11
  v_mul_f32 v10, v10, v12
  v_cvt_pk_bf16_f32 v13, v9, v10
  ds_write_b16 v6, v13 offset:512
  ds_write_b16_d16_hi v6, v13 offset:640
  v_lshlrev_b32 v11, 16, v47
  v_and_b32 v12, 0xffff0000, v47
  v_and_b32 v13, 0xffff0000, v29
  v_mul_f32 v11, v11, v13
  v_and_b32 v13, 0xffff0000, v31
  v_mul_f32 v12, v12, v13
  v_cvt_pk_bf16_f32 v13, v11, v12
  v_lshlrev_b32 v11, 16, v13
  v_and_b32 v12, 0xffff0000, v13
  v_mov_b32 v9, v11
  v_mov_b32 v10, v12
  v_lshlrev_b32 v11, 16, v43
  v_and_b32 v12, 0xffff0000, v43
  v_lshlrev_b32 v13, 16, v29
  v_mul_f32 v11, v11, v13
  v_lshlrev_b32 v13, 16, v31
  v_mul_f32 v12, v12, v13
  v_cvt_pk_bf16_f32 v13, v11, v12
  v_lshlrev_b32 v11, 16, v13
  v_and_b32 v12, 0xffff0000, v13
  v_add_f32 v9, v9, v11
  v_add_f32 v10, v10, v12
  v_cvt_pk_bf16_f32 v13, v9, v10
  v_lshlrev_b32 v9, 16, v13
  v_and_b32 v10, 0xffff0000, v13
  v_lshlrev_b32 v11, 16, v39
  v_and_b32 v12, 0xffff0000, v39
  v_and_b32 v13, 0xffff0000, v28
  v_mul_f32 v11, v11, v13
  v_and_b32 v13, 0xffff0000, v30
  v_mul_f32 v12, v12, v13
  v_cvt_pk_bf16_f32 v13, v11, v12
  v_lshlrev_b32 v11, 16, v13
  v_and_b32 v12, 0xffff0000, v13
  v_add_f32 v9, v9, v11
  v_add_f32 v10, v10, v12
  v_cvt_pk_bf16_f32 v13, v9, v10
  v_lshlrev_b32 v9, 16, v13
  v_and_b32 v10, 0xffff0000, v13
  v_lshlrev_b32 v11, 16, v35
  v_and_b32 v12, 0xffff0000, v35
  v_lshlrev_b32 v13, 16, v28
  v_mul_f32 v11, v11, v13
  v_lshlrev_b32 v13, 16, v30
  v_mul_f32 v12, v12, v13
  v_cvt_pk_bf16_f32 v13, v11, v12
  v_lshlrev_b32 v11, 16, v13
  v_and_b32 v12, 0xffff0000, v13
  v_add_f32 v9, v9, v11
  v_add_f32 v10, v10, v12
  v_cvt_pk_bf16_f32 v13, v9, v10
  v_lshlrev_b32 v9, 16, v13
  v_and_b32 v10, 0xffff0000, v13
  v_lshlrev_b32 v11, 16, v51
  v_and_b32 v12, 0xffff0000, v51
  v_mul_f32 v9, v9, v11
  v_mul_f32 v10, v10, v12
  v_cvt_pk_bf16_f32 v13, v9, v10
  ds_write_b16 v6, v13 offset:768
  ds_write_b16_d16_hi v6, v13 offset:896
  s_waitcnt vmcnt(0)
  v_lshlrev_b32 v11, 16, v64
  v_and_b32 v12, 0xffff0000, v64
  v_and_b32 v13, 0xffff0000, v17
  v_mul_f32 v11, v11, v13
  v_and_b32 v13, 0xffff0000, v19
  v_mul_f32 v12, v12, v13
  v_cvt_pk_bf16_f32 v13, v11, v12
  v_lshlrev_b32 v11, 16, v13
  v_and_b32 v12, 0xffff0000, v13
  v_mov_b32 v9, v11
  v_mov_b32 v10, v12
  v_lshlrev_b32 v11, 16, v60
  v_and_b32 v12, 0xffff0000, v60
  v_lshlrev_b32 v13, 16, v17
  v_mul_f32 v11, v11, v13
  v_lshlrev_b32 v13, 16, v19
  v_mul_f32 v12, v12, v13
  v_cvt_pk_bf16_f32 v13, v11, v12
  v_lshlrev_b32 v11, 16, v13
  v_and_b32 v12, 0xffff0000, v13
  v_add_f32 v9, v9, v11
  v_add_f32 v10, v10, v12
  v_cvt_pk_bf16_f32 v13, v9, v10
  v_lshlrev_b32 v9, 16, v13
  v_and_b32 v10, 0xffff0000, v13
  v_lshlrev_b32 v11, 16, v56
  v_and_b32 v12, 0xffff0000, v56
  v_and_b32 v13, 0xffff0000, v16
  v_mul_f32 v11, v11, v13
  v_and_b32 v13, 0xffff0000, v18
  v_mul_f32 v12, v12, v13
  v_cvt_pk_bf16_f32 v13, v11, v12
  v_lshlrev_b32 v11, 16, v13
  v_and_b32 v12, 0xffff0000, v13
  v_add_f32 v9, v9, v11
  v_add_f32 v10, v10, v12
  v_cvt_pk_bf16_f32 v13, v9, v10
  v_lshlrev_b32 v9, 16, v13
  v_and_b32 v10, 0xffff0000, v13
  v_lshlrev_b32 v11, 16, v52
  v_and_b32 v12, 0xffff0000, v52
  v_lshlrev_b32 v13, 16, v16
  v_mul_f32 v11, v11, v13
  v_lshlrev_b32 v13, 16, v18
  v_mul_f32 v12, v12, v13
  v_cvt_pk_bf16_f32 v13, v11, v12
  v_lshlrev_b32 v11, 16, v13
  v_and_b32 v12, 0xffff0000, v13
  v_add_f32 v9, v9, v11
  v_add_f32 v10, v10, v12
  v_cvt_pk_bf16_f32 v13, v9, v10
  v_lshlrev_b32 v9, 16, v13
  v_and_b32 v10, 0xffff0000, v13
  v_lshlrev_b32 v11, 16, v68
  v_and_b32 v12, 0xffff0000, v68
  v_mul_f32 v9, v9, v11
  v_mul_f32 v10, v10, v12
  v_cvt_pk_bf16_f32 v13, v9, v10
  ds_write_b16 v6, v13 offset:64
  ds_write_b16_d16_hi v6, v13 offset:192
  v_lshlrev_b32 v11, 16, v65
  v_and_b32 v12, 0xffff0000, v65
  v_and_b32 v13, 0xffff0000, v21
  v_mul_f32 v11, v11, v13
  v_and_b32 v13, 0xffff0000, v23
  v_mul_f32 v12, v12, v13
  v_cvt_pk_bf16_f32 v13, v11, v12
  v_lshlrev_b32 v11, 16, v13
  v_and_b32 v12, 0xffff0000, v13
  v_mov_b32 v9, v11
  v_mov_b32 v10, v12
  v_lshlrev_b32 v11, 16, v61
  v_and_b32 v12, 0xffff0000, v61
  v_lshlrev_b32 v13, 16, v21
  v_mul_f32 v11, v11, v13
  v_lshlrev_b32 v13, 16, v23
  v_mul_f32 v12, v12, v13
  v_cvt_pk_bf16_f32 v13, v11, v12
  v_lshlrev_b32 v11, 16, v13
  v_and_b32 v12, 0xffff0000, v13
  v_add_f32 v9, v9, v11
  v_add_f32 v10, v10, v12
  v_cvt_pk_bf16_f32 v13, v9, v10
  v_lshlrev_b32 v9, 16, v13
  v_and_b32 v10, 0xffff0000, v13
  v_lshlrev_b32 v11, 16, v57
  v_and_b32 v12, 0xffff0000, v57
  v_and_b32 v13, 0xffff0000, v20
  v_mul_f32 v11, v11, v13
  v_and_b32 v13, 0xffff0000, v22
  v_mul_f32 v12, v12, v13
  v_cvt_pk_bf16_f32 v13, v11, v12
  v_lshlrev_b32 v11, 16, v13
  v_and_b32 v12, 0xffff0000, v13
  v_add_f32 v9, v9, v11
  v_add_f32 v10, v10, v12
  v_cvt_pk_bf16_f32 v13, v9, v10
  v_lshlrev_b32 v9, 16, v13
  v_and_b32 v10, 0xffff0000, v13
  v_lshlrev_b32 v11, 16, v53
  v_and_b32 v12, 0xffff0000, v53
  v_lshlrev_b32 v13, 16, v20
  v_mul_f32 v11, v11, v13
  v_lshlrev_b32 v13, 16, v22
  v_mul_f32 v12, v12, v13
  v_cvt_pk_bf16_f32 v13, v11, v12
  v_lshlrev_b32 v11, 16, v13
  v_and_b32 v12, 0xffff0000, v13
  v_add_f32 v9, v9, v11
  v_add_f32 v10, v10, v12
  v_cvt_pk_bf16_f32 v13, v9, v10
  v_lshlrev_b32 v9, 16, v13
  v_and_b32 v10, 0xffff0000, v13
  v_lshlrev_b32 v11, 16, v69
  v_and_b32 v12, 0xffff0000, v69
  v_mul_f32 v9, v9, v11
  v_mul_f32 v10, v10, v12
  v_cvt_pk_bf16_f32 v13, v9, v10
  ds_write_b16 v6, v13 offset:320
  ds_write_b16_d16_hi v6, v13 offset:448
  v_lshlrev_b32 v11, 16, v66
  v_and_b32 v12, 0xffff0000, v66
  v_and_b32 v13, 0xffff0000, v25
  v_mul_f32 v11, v11, v13
  v_and_b32 v13, 0xffff0000, v27
  v_mul_f32 v12, v12, v13
  v_cvt_pk_bf16_f32 v13, v11, v12
  v_lshlrev_b32 v11, 16, v13
  v_and_b32 v12, 0xffff0000, v13
  v_mov_b32 v9, v11
  v_mov_b32 v10, v12
  v_lshlrev_b32 v11, 16, v62
  v_and_b32 v12, 0xffff0000, v62
  v_lshlrev_b32 v13, 16, v25
  v_mul_f32 v11, v11, v13
  v_lshlrev_b32 v13, 16, v27
  v_mul_f32 v12, v12, v13
  v_cvt_pk_bf16_f32 v13, v11, v12
  v_lshlrev_b32 v11, 16, v13
  v_and_b32 v12, 0xffff0000, v13
  v_add_f32 v9, v9, v11
  v_add_f32 v10, v10, v12
  v_cvt_pk_bf16_f32 v13, v9, v10
  v_lshlrev_b32 v9, 16, v13
  v_and_b32 v10, 0xffff0000, v13
  v_lshlrev_b32 v11, 16, v58
  v_and_b32 v12, 0xffff0000, v58
  v_and_b32 v13, 0xffff0000, v24
  v_mul_f32 v11, v11, v13
  v_and_b32 v13, 0xffff0000, v26
  v_mul_f32 v12, v12, v13
  v_cvt_pk_bf16_f32 v13, v11, v12
  v_lshlrev_b32 v11, 16, v13
  v_and_b32 v12, 0xffff0000, v13
  v_add_f32 v9, v9, v11
  v_add_f32 v10, v10, v12
  v_cvt_pk_bf16_f32 v13, v9, v10
  v_lshlrev_b32 v9, 16, v13
  v_and_b32 v10, 0xffff0000, v13
  v_lshlrev_b32 v11, 16, v54
  v_and_b32 v12, 0xffff0000, v54
  v_lshlrev_b32 v13, 16, v24
  v_mul_f32 v11, v11, v13
  v_lshlrev_b32 v13, 16, v26
  v_mul_f32 v12, v12, v13
  v_cvt_pk_bf16_f32 v13, v11, v12
  v_lshlrev_b32 v11, 16, v13
  v_and_b32 v12, 0xffff0000, v13
  v_add_f32 v9, v9, v11
  v_add_f32 v10, v10, v12
  v_cvt_pk_bf16_f32 v13, v9, v10
  v_lshlrev_b32 v9, 16, v13
  v_and_b32 v10, 0xffff0000, v13
  v_lshlrev_b32 v11, 16, v70
  v_and_b32 v12, 0xffff0000, v70
  v_mul_f32 v9, v9, v11
  v_mul_f32 v10, v10, v12
  v_cvt_pk_bf16_f32 v13, v9, v10
  ds_write_b16 v6, v13 offset:576
  ds_write_b16_d16_hi v6, v13 offset:704
  v_lshlrev_b32 v11, 16, v67
  v_and_b32 v12, 0xffff0000, v67
  v_and_b32 v13, 0xffff0000, v29
  v_mul_f32 v11, v11, v13
  v_and_b32 v13, 0xffff0000, v31
  v_mul_f32 v12, v12, v13
  v_cvt_pk_bf16_f32 v13, v11, v12
  v_lshlrev_b32 v11, 16, v13
  v_and_b32 v12, 0xffff0000, v13
  v_mov_b32 v9, v11
  v_mov_b32 v10, v12
  v_lshlrev_b32 v11, 16, v63
  v_and_b32 v12, 0xffff0000, v63
  v_lshlrev_b32 v13, 16, v29
  v_mul_f32 v11, v11, v13
  v_lshlrev_b32 v13, 16, v31
  v_mul_f32 v12, v12, v13
  v_cvt_pk_bf16_f32 v13, v11, v12
  v_lshlrev_b32 v11, 16, v13
  v_and_b32 v12, 0xffff0000, v13
  v_add_f32 v9, v9, v11
  v_add_f32 v10, v10, v12
  v_cvt_pk_bf16_f32 v13, v9, v10
  v_lshlrev_b32 v9, 16, v13
  v_and_b32 v10, 0xffff0000, v13
  v_lshlrev_b32 v11, 16, v59
  v_and_b32 v12, 0xffff0000, v59
  v_and_b32 v13, 0xffff0000, v28
  v_mul_f32 v11, v11, v13
  v_and_b32 v13, 0xffff0000, v30
  v_mul_f32 v12, v12, v13
  v_cvt_pk_bf16_f32 v13, v11, v12
  v_lshlrev_b32 v11, 16, v13
  v_and_b32 v12, 0xffff0000, v13
  v_add_f32 v9, v9, v11
  v_add_f32 v10, v10, v12
  v_cvt_pk_bf16_f32 v13, v9, v10
  v_lshlrev_b32 v9, 16, v13
  v_and_b32 v10, 0xffff0000, v13
  v_lshlrev_b32 v11, 16, v55
  v_and_b32 v12, 0xffff0000, v55
  v_lshlrev_b32 v13, 16, v28
  v_mul_f32 v11, v11, v13
  v_lshlrev_b32 v13, 16, v30
  v_mul_f32 v12, v12, v13
  v_cvt_pk_bf16_f32 v13, v11, v12
  v_lshlrev_b32 v11, 16, v13
  v_and_b32 v12, 0xffff0000, v13
  v_add_f32 v9, v9, v11
  v_add_f32 v10, v10, v12
  v_cvt_pk_bf16_f32 v13, v9, v10
  v_lshlrev_b32 v9, 16, v13
  v_and_b32 v10, 0xffff0000, v13
  v_lshlrev_b32 v11, 16, v71
  v_and_b32 v12, 0xffff0000, v71
  v_mul_f32 v9, v9, v11
  v_mul_f32 v10, v10, v12
  v_cvt_pk_bf16_f32 v13, v9, v10
  ds_write_b16 v6, v13 offset:832
  ds_write_b16_d16_hi v6, v13 offset:960
  s_waitcnt lgkmcnt(0)
  s_barrier
  v_lshrrev_b32 v1, 3, v0
  v_and_b32 v2, 7, v0
  v_lshlrev_b32 v3, 7, v1
  v_lshl_add_u32 v3, v2, 4, v3
  v_add_u32 v4, s5, v1
  v_lshlrev_b32 v4, 12, v4
  v_lshl_add_u32 v4, v2, 4, v4
  s_lshl_b32 s6, s4, 1
  v_add_u32 v4, s6, v4
  ds_read_b128 v[8:11], v3
  ds_read_b128 v[12:15], v3 offset:4096
  v_add_u32 v5, 0x20000, v4
  s_waitcnt lgkmcnt(1)
  buffer_store_dwordx4 v[8:11], v4, s[20:23], 0 offen
  s_waitcnt lgkmcnt(0)
  buffer_store_dwordx4 v[12:15], v5, s[20:23], 0 offen
  s_endpgm
PREP_TR:
  s_load_dwordx2 s[42:43], s[0:1], 56
  s_load_dwordx2 s[44:45], s[0:1], 64
  s_load_dwordx2 s[46:47], s[0:1], 72
  s_sub_u32 s3, s2, 768
  s_lshl_b32 s3, s3, 12
  v_lshlrev_b32 v1, 4, v0
  v_add_u32 v1, s3, v1
  s_waitcnt lgkmcnt(0)
  s_mov_b32 s8, s42
  s_mov_b32 s9, s43
  s_and_b32 s9, s9, 0xffff
  s_mov_b32 s10, 0x158000
  s_mov_b32 s11, 0x20000
  s_mov_b32 s12, s44
  s_mov_b32 s13, s45
  s_and_b32 s13, s13, 0xffff
  s_mov_b32 s14, 0x158000
  s_mov_b32 s15, 0x20000
  s_mov_b32 s16, s46
  s_mov_b32 s17, s47
  s_and_b32 s17, s17, 0xffff
  s_mov_b32 s18, 0x158000
  s_mov_b32 s19, 0x20000
  buffer_load_dwordx4 v[4:7], v1, s[8:11], 0 offen
  buffer_load_dwordx4 v[8:11], v1, s[12:15], 0 offen
  buffer_load_dwordx4 v[12:15], v1, s[16:19], 0 offen
  v_add_u32 v1, 352256, v1
  buffer_load_dwordx4 v[4:7], v1, s[8:11], 0 offen
  buffer_load_dwordx4 v[8:11], v1, s[12:15], 0 offen
  buffer_load_dwordx4 v[12:15], v1, s[16:19], 0 offen
  v_add_u32 v1, 352256, v1
  buffer_load_dwordx4 v[4:7], v1, s[8:11], 0 offen
  buffer_load_dwordx4 v[8:11], v1, s[12:15], 0 offen
  buffer_load_dwordx4 v[12:15], v1, s[16:19], 0 offen
  v_add_u32 v1, 352256, v1
  buffer_load_dwordx4 v[4:7], v1, s[8:11], 0 offen
  buffer_load_dwordx4 v[8:11], v1, s[12:15], 0 offen
  buffer_load_dwordx4 v[12:15], v1, s[16:19], 0 offen
  v_add_u32 v1, 352256, v1
  s_waitcnt vmcnt(0)
PREP_END:
  s_endpgm
.globl mid_kernel
.p2align 8
.type mid_kernel,@function
mid_kernel:
  s_cmp_ge_u32 s2, 240
  s_cbranch_scc1 MID_CONV
  s_load_dwordx2 s[40:41], s[0:1], 96
  s_load_dwordx2 s[42:43], s[0:1], 56
  s_load_dwordx2 s[44:45], s[0:1], 64
  s_and_b32 s3, s2, 15
  s_lshr_b32 s4, s2, 4
  s_mul_i32 s4, s4, 6
  s_min_u32 s4, s4, 80
  v_lshrrev_b32 v1, 6, v0
  s_nop 0
  v_readfirstlane_b32 s5, v1
  v_and_b32 v2, 63, v0
  v_and_b32 v3, 15, v2
  v_lshrrev_b32 v4, 4, v2
  s_and_b32 s33, s5, 1
  s_lshr_b32 s34, s5, 1
  s_mul_i32 s6, s33, 192
  s_mov_b32 s7, 43691
  s_add_u32 s30, s6, 0
  v_add_u32 v6, s30, v2
  v_mul_lo_u32 v7, v6, s7
  v_lshrrev_b32 v7, 19, v7
  v_mul_u32_u24 v8, 12, v7
  v_sub_u32 v6, v6, v8
  v_mul_u32_u24 v7, 2752, v7
  v_lshl_add_u32 v10, v6, 4, v7
  s_lshl_b32 s25, s30, 4
  s_add_u32 s30, s6, 64
  v_add_u32 v6, s30, v2
  v_mul_lo_u32 v7, v6, s7
  v_lshrrev_b32 v7, 19, v7
  v_mul_u32_u24 v8, 12, v7
  v_sub_u32 v6, v6, v8
  v_mul_u32_u24 v7, 2752, v7
  v_lshl_add_u32 v11, v6, 4, v7
  s_lshl_b32 s26, s30, 4
  s_add_u32 s30, s6, 128
  v_add_u32 v6, s30, v2
  v_mul_lo_u32 v7, v6, s7
  v_lshrrev_b32 v7, 19, v7
  v_mul_u32_u24 v8, 12, v7
  v_sub_u32 v6, v6, v8
  v_mul_u32_u24 v7, 2752, v7
  v_lshl_add_u32 v12, v6, 4, v7
  s_lshl_b32 s27, s30, 4
  s_mul_i32 s30, s34, 6144
  s_add_u32 s25, s25, s30
  s_add_u32 s26, s26, s30
  s_add_u32 s27, s27, s30
  s_lshl_b32 s20, s4, 5
  v_lshlrev_b32 v5, 4, v2
  s_lshl_b32 s30, s3, 3
  s_lshl_b32 s31, s5, 1
  s_add_u32 s30, s30, s31
  s_lshl_b32 s21, s30, 14
  s_add_u32 s22, s21, 0x4000
  s_lshl_b32 s23, s5, 11
  s_add_u32 s23, s23, 12288
  s_add_u32 s24, s23, 1024
  s_waitcnt lgkmcnt(0)
  s_cmp_eq_u32 s34, 0
  s_cselect_b32 s46, s42, s44
  s_cselect_b32 s47, s43, s45
  s_mov_b32 s8, s40
  s_mov_b32 s9, s41
  s_and_b32 s9, s9, 0xffff
  s_mov_b32 s10, 0x200000
  s_mov_b32 s11, 0x20000
  s_add_u32 s12, s40, 0x900000
  s_addc_u32 s13, s41, 0
  s_and_b32 s13, s13, 0xffff
  s_mov_b32 s14, 0x560000
  s_mov_b32 s15, 0x20000
  s_mov_b32 s16, s46
  s_mov_b32 s17, s47
  s_and_b32 s17, s17, 0xffff
  s_mov_b32 s18, 0x158000
  s_mov_b32 s19, 0x20000
  s_add_u32 m0, s25, 0
  s_nop 0
  buffer_load_dwordx4 v10, s[16:19], s20 offen lds
  s_add_u32 m0, s26, 0
  s_nop 0
  buffer_load_dwordx4 v11, s[16:19], s20 offen lds
  s_add_u32 m0, s27, 0
  s_nop 0
  buffer_load_dwordx4 v12, s[16:19], s20 offen lds
  s_add_u32 m0, s23, 0
  s_nop 0
  buffer_load_dwordx4 v5, s[8:11], s21 offen lds
  s_add_u32 m0, s24, 0
  s_nop 0
  buffer_load_dwordx4 v5, s[8:11], s22 offen lds
  v_add_u32 v5, 0x400, v5
  s_add_u32 s20, s20, 88064
  s_add_u32 m0, s25, 20480
  s_nop 0
  buffer_load_dwordx4 v10, s[16:19], s20 offen lds
  s_add_u32 m0, s26, 20480
  s_nop 0
  buffer_load_dwordx4 v11, s[16:19], s20 offen lds
  s_add_u32 m0, s27, 20480
  s_nop 0
  buffer_load_dwordx4 v12, s[16:19], s20 offen lds
  s_add_u32 m0, s23, 20480
  s_nop 0
  buffer_load_dwordx4 v5, s[8:11], s21 offen lds
  s_add_u32 m0, s24, 20480
  s_nop 0
  buffer_load_dwordx4 v5, s[8:11], s22 offen lds
  v_add_u32 v5, 0x400, v5
  s_add_u32 s20, s20, 88064
  s_add_u32 m0, s25, 40960
  s_nop 0
  buffer_load_dwordx4 v10, s[16:19], s20 offen lds
  s_add_u32 m0, s26, 40960
  s_nop 0
  buffer_load_dwordx4 v11, s[16:19], s20 offen lds
  s_add_u32 m0, s27, 40960
  s_nop 0
  buffer_load_dwordx4 v12, s[16:19], s20 offen lds
  s_add_u32 m0, s23, 40960
  s_nop 0
  buffer_load_dwordx4 v5, s[8:11], s21 offen lds
  s_add_u32 m0, s24, 40960
  s_nop 0
  buffer_load_dwordx4 v5, s[8:11], s22 offen lds
  v_add_u32 v5, 0x400, v5
  s_add_u32 s20, s20, 88064
  v_lshrrev_b32 v6, 2, v3
  v_lshl_add_u32 v6, v4, 3, v6
  v_mul_u32_u24 v6, 192, v6
  v_and_b32 v7, 3, v3
  v_lshl_add_u32 v6, v7, 3, v6
  s_mul_i32 s35, s34, 96
  v_add_u32 v6, s35, v6
  v_lshlrev_b32 v7, 4, v2
  s_lshl_b32 s35, s33, 12
  s_add_u32 s35, s35, 12288
  v_add_u32 v7, s35, v7
  v_add_u32 v16, 0, v6
  v_add_u32 v22, 0, v7
  v_add_u32 v17, 20480, v6
  v_add_u32 v23, 20480, v7
  v_add_u32 v18, 40960, v6
  v_add_u32 v24, 40960, v7
  v_mov_b32 v32, 0
  v_mov_b32 v33, 0
  v_mov_b32 v34, 0
  v_mov_b32 v35, 0
  v_mov_b32 v36, 0
  v_mov_b32 v37, 0
  v_mov_b32 v38, 0
  v_mov_b32 v39, 0
  v_mov_b32 v40, 0
  v_mov_b32 v41, 0
  v_mov_b32 v42, 0
  v_mov_b32 v43, 0
  v_mov_b32 v44, 0
  v_mov_b32 v45, 0
  v_mov_b32 v46, 0
  v_mov_b32 v47, 0
  v_mov_b32 v48, 0
  v_mov_b32 v49, 0
  v_mov_b32 v50, 0
  v_mov_b32 v51, 0
  v_mov_b32 v52, 0
  v_mov_b32 v53, 0
  v_mov_b32 v54, 0
  v_mov_b32 v55, 0
  v_mov_b32 v56, 0
  v_mov_b32 v57, 0
  v_mov_b32 v58, 0
  v_mov_b32 v59, 0
  v_mov_b32 v60, 0
  v_mov_b32 v61, 0
  v_mov_b32 v62, 0
  v_mov_b32 v63, 0
  v_mov_b32 v64, 0
  v_mov_b32 v65, 0
  v_mov_b32 v66, 0
  v_mov_b32 v67, 0
  v_mov_b32 v68, 0
  v_mov_b32 v69, 0
  v_mov_b32 v70, 0
  v_mov_b32 v71, 0
  v_mov_b32 v72, 0
  v_mov_b32 v73, 0
  v_mov_b32 v74, 0
  v_mov_b32 v75, 0
  v_mov_b32 v76, 0
  v_mov_b32 v77, 0
  v_mov_b32 v78, 0
  v_mov_b32 v79, 0
  v_mov_b32 v80, 0
  v_mov_b32 v81, 0
  v_mov_b32 v82, 0
  v_mov_b32 v83, 0
  v_mov_b32 v84, 0
  v_mov_b32 v85, 0
  v_mov_b32 v86, 0
  v_mov_b32 v87, 0
  v_mov_b32 v88, 0
  v_mov_b32 v89, 0
  v_mov_b32 v90, 0
  v_mov_b32 v91, 0
  v_mov_b32 v92, 0
  v_mov_b32 v93, 0
  v_mov_b32 v94, 0
  v_mov_b32 v95, 0
  v_mov_b32 v96, 0
  v_mov_b32 v97, 0
  v_mov_b32 v98, 0
  v_mov_b32 v99, 0
  v_mov_b32 v100, 0
  v_mov_b32 v101, 0
  v_mov_b32 v102, 0
  v_mov_b32 v103, 0
  v_mov_b32 v104, 0
  v_mov_b32 v105, 0
  v_mov_b32 v106, 0
  v_mov_b32 v107, 0
  v_mov_b32 v108, 0
  v_mov_b32 v109, 0
  v_mov_b32 v110, 0
  v_mov_b32 v111, 0
  v_mov_b32 v112, 0
  v_mov_b32 v113, 0
  v_mov_b32 v114, 0
  v_mov_b32 v115, 0
  v_mov_b32 v116, 0
  v_mov_b32 v117, 0
  v_mov_b32 v118, 0
  v_mov_b32 v119, 0
  v_mov_b32 v120, 0
  v_mov_b32 v121, 0
  v_mov_b32 v122, 0
  v_mov_b32 v123, 0
  v_mov_b32 v124, 0
  v_mov_b32 v125, 0
  v_mov_b32 v126, 0
  v_mov_b32 v127, 0
  s_waitcnt vmcnt(10)
  s_barrier
  ds_read_b128 v[176:179], v22 offset:0
  ds_read_b64_tr_b16 v[128:129], v16 offset:0
  ds_read_b64_tr_b16 v[130:131], v16 offset:768
  ds_read_b128 v[180:183], v22 offset:1024
  ds_read_b64_tr_b16 v[132:133], v16 offset:6144
  ds_read_b64_tr_b16 v[134:135], v16 offset:6912
  ds_read_b128 v[184:187], v22 offset:2048
  ds_read_b64_tr_b16 v[136:137], v16 offset:32
  ds_read_b64_tr_b16 v[138:139], v16 offset:800
  ds_read_b128 v[188:191], v22 offset:3072
  ds_read_b64_tr_b16 v[140:141], v16 offset:6176
  ds_read_b64_tr_b16 v[142:143], v16 offset:6944
  ds_read_b64_tr_b16 v[144:145], v16 offset:64
  ds_read_b64_tr_b16 v[146:147], v16 offset:832
  ds_read_b64_tr_b16 v[148:149], v16 offset:6208
  ds_read_b64_tr_b16 v[150:151], v16 offset:6976
  s_waitcnt lgkmcnt(0)
  s_waitcnt vmcnt(5)
  s_barrier
  s_add_u32 m0, s25, 0
  s_nop 0
  buffer_load_dwordx4 v10, s[16:19], s20 offen lds
  s_add_u32 m0, s26, 0
  s_nop 0
  buffer_load_dwordx4 v11, s[16:19], s20 offen lds
  s_add_u32 m0, s27, 0
  s_nop 0
  buffer_load_dwordx4 v12, s[16:19], s20 offen lds
  s_add_u32 m0, s23, 0
  s_nop 0
  buffer_load_dwordx4 v5, s[8:11], s21 offen lds
  s_add_u32 m0, s24, 0
  s_nop 0
  buffer_load_dwordx4 v5, s[8:11], s22 offen lds
  v_add_u32 v5, 0x400, v5
  s_add_u32 s20, s20, 88064
  ds_read_b128 v[192:195], v23 offset:0
  v_mfma_f32_16x16x32_bf16 v[32:35], v[128:131], v[176:179], v[32:35]
  ds_read_b64_tr_b16 v[152:153], v17 offset:0
  v_mfma_f32_16x16x32_bf16 v[36:39], v[128:131], v[180:183], v[36:39]
  ds_read_b64_tr_b16 v[154:155], v17 offset:768
  v_mfma_f32_16x16x32_bf16 v[40:43], v[128:131], v[184:187], v[40:43]
  ds_read_b128 v[196:199], v23 offset:1024
  v_mfma_f32_16x16x32_bf16 v[44:47], v[128:131], v[188:191], v[44:47]
  ds_read_b64_tr_b16 v[156:157], v17 offset:6144
  v_mfma_f32_16x16x32_bf16 v[48:51], v[132:135], v[176:179], v[48:51]
  ds_read_b64_tr_b16 v[158:159], v17 offset:6912
  v_mfma_f32_16x16x32_bf16 v[52:55], v[132:135], v[180:183], v[52:55]
  ds_read_b128 v[200:203], v23 offset:2048
  v_mfma_f32_16x16x32_bf16 v[56:59], v[132:135], v[184:187], v[56:59]
  ds_read_b64_tr_b16 v[160:161], v17 offset:32
  v_mfma_f32_16x16x32_bf16 v[60:63], v[132:135], v[188:191], v[60:63]
  ds_read_b64_tr_b16 v[162:163], v17 offset:800
  v_mfma_f32_16x16x32_bf16 v[64:67], v[136:139], v[176:179], v[64:67]
  ds_read_b128 v[204:207], v23 offset:3072
  v_mfma_f32_16x16x32_bf16 v[68:71], v[136:139], v[180:183], v[68:71]
  ds_read_b64_tr_b16 v[164:165], v17 offset:6176
  v_mfma_f32_16x16x32_bf16 v[72:75], v[136:139], v[184:187], v[72:75]
  ds_read_b64_tr_b16 v[166:167], v17 offset:6944
  v_mfma_f32_16x16x32_bf16 v[76:79], v[136:139], v[188:191], v[76:79]
  ds_read_b64_tr_b16 v[168:169], v17 offset:64
  v_mfma_f32_16x16x32_bf16 v[80:83], v[140:143], v[176:179], v[80:83]
  ds_read_b64_tr_b16 v[170:171], v17 offset:832
  v_mfma_f32_16x16x32_bf16 v[84:87], v[140:143], v[180:183], v[84:87]
  ds_read_b64_tr_b16 v[172:173], v17 offset:6208
  v_mfma_f32_16x16x32_bf16 v[88:91], v[140:143], v[184:187], v[88:91]
  ds_read_b64_tr_b16 v[174:175], v17 offset:6976
  v_mfma_f32_16x16x32_bf16 v[92:95], v[140:143], v[188:191], v[92:95]
  v_mfma_f32_16x16x32_bf16 v[96:99], v[144:147], v[176:179], v[96:99]
  v_mfma_f32_16x16x32_bf16 v[100:103], v[144:147], v[180:183], v[100:103]
  v_mfma_f32_16x16x32_bf16 v[104:107], v[144:147], v[184:187], v[104:107]
  v_mfma_f32_16x16x32_bf16 v[108:111], v[144:147], v[188:191], v[108:111]
  v_mfma_f32_16x16x32_bf16 v[112:115], v[148:151], v[176:179], v[112:115]
  v_mfma_f32_16x16x32_bf16 v[116:119], v[148:151], v[180:183], v[116:119]
  v_mfma_f32_16x16x32_bf16 v[120:123], v[148:151], v[184:187], v[120:123]
  v_mfma_f32_16x16x32_bf16 v[124:127], v[148:151], v[188:191], v[124:127]
  s_waitcnt lgkmcnt(0)
  s_waitcnt vmcnt(5)
  s_barrier
  s_add_u32 m0, s25, 20480
  s_nop 0
  buffer_load_dwordx4 v10, s[16:19], s20 offen lds
  s_add_u32 m0, s26, 20480
  s_nop 0
  buffer_load_dwordx4 v11, s[16:19], s20 offen lds
  s_add_u32 m0, s27, 20480
  s_nop 0
  buffer_load_dwordx4 v12, s[16:19], s20 offen lds
  s_add_u32 m0, s23, 20480
  s_nop 0
  buffer_load_dwordx4 v5, s[8:11], s21 offen lds
  s_add_u32 m0, s24, 20480
  s_nop 0
  buffer_load_dwordx4 v5, s[8:11], s22 offen lds
  v_add_u32 v5, 0x400, v5
  s_add_u32 s20, s20, 88064
  ds_read_b128 v[176:179], v24 offset:0
  v_mfma_f32_16x16x32_bf16 v[32:35], v[152:155], v[192:195], v[32:35]
  ds_read_b64_tr_b16 v[128:129], v18 offset:0
  v_mfma_f32_16x16x32_bf16 v[36:39], v[152:155], v[196:199], v[36:39]
  ds_read_b64_tr_b16 v[130:131], v18 offset:768
  v_mfma_f32_16x16x32_bf16 v[40:43], v[152:155], v[200:203], v[40:43]
  ds_read_b128 v[180:183], v24 offset:1024
  v_mfma_f32_16x16x32_bf16 v[44:47], v[152:155], v[204:207], v[44:47]
  ds_read_b64_tr_b16 v[132:133], v18 offset:6144
  v_mfma_f32_16x16x32_bf16 v[48:51], v[156:159], v[192:195], v[48:51]
  ds_read_b64_tr_b16 v[134:135], v18 offset:6912
  v_mfma_f32_16x16x32_bf16 v[52:55], v[156:159], v[196:199], v[52:55]
  ds_read_b128 v[184:187], v24 offset:2048
  v_mfma_f32_16x16x32_bf16 v[56:59], v[156:159], v[200:203], v[56:59]
  ds_read_b64_tr_b16 v[136:137], v18 offset:32
  v_mfma_f32_16x16x32_bf16 v[60:63], v[156:159], v[204:207], v[60:63]
  ds_read_b64_tr_b16 v[138:139], v18 offset:800
  v_mfma_f32_16x16x32_bf16 v[64:67], v[160:163], v[192:195], v[64:67]
  ds_read_b128 v[188:191], v24 offset:3072
  v_mfma_f32_16x16x32_bf16 v[68:71], v[160:163], v[196:199], v[68:71]
  ds_read_b64_tr_b16 v[140:141], v18 offset:6176
  v_mfma_f32_16x16x32_bf16 v[72:75], v[160:163], v[200:203], v[72:75]
  ds_read_b64_tr_b16 v[142:143], v18 offset:6944
  v_mfma_f32_16x16x32_bf16 v[76:79], v[160:163], v[204:207], v[76:79]
  ds_read_b64_tr_b16 v[144:145], v18 offset:64
  v_mfma_f32_16x16x32_bf16 v[80:83], v[164:167], v[192:195], v[80:83]
  ds_read_b64_tr_b16 v[146:147], v18 offset:832
  v_mfma_f32_16x16x32_bf16 v[84:87], v[164:167], v[196:199], v[84:87]
  ds_read_b64_tr_b16 v[148:149], v18 offset:6208
  v_mfma_f32_16x16x32_bf16 v[88:91], v[164:167], v[200:203], v[88:91]
  ds_read_b64_tr_b16 v[150:151], v18 offset:6976
  v_mfma_f32_16x16x32_bf16 v[92:95], v[164:167], v[204:207], v[92:95]
  v_mfma_f32_16x16x32_bf16 v[96:99], v[168:171], v[192:195], v[96:99]
  v_mfma_f32_16x16x32_bf16 v[100:103], v[168:171], v[196:199], v[100:103]
  v_mfma_f32_16x16x32_bf16 v[104:107], v[168:171], v[200:203], v[104:107]
  v_mfma_f32_16x16x32_bf16 v[108:111], v[168:171], v[204:207], v[108:111]
  v_mfma_f32_16x16x32_bf16 v[112:115], v[172:175], v[192:195], v[112:115]
  v_mfma_f32_16x16x32_bf16 v[116:119], v[172:175], v[196:199], v[116:119]
  v_mfma_f32_16x16x32_bf16 v[120:123], v[172:175], v[200:203], v[120:123]
  v_mfma_f32_16x16x32_bf16 v[124:127], v[172:175], v[204:207], v[124:127]
  s_waitcnt lgkmcnt(0)
  s_waitcnt vmcnt(5)
  s_barrier
  s_add_u32 m0, s25, 40960
  s_nop 0
  buffer_load_dwordx4 v10, s[16:19], s20 offen lds
  s_add_u32 m0, s26, 40960
  s_nop 0
  buffer_load_dwordx4 v11, s[16:19], s20 offen lds
  s_add_u32 m0, s27, 40960
  s_nop 0
  buffer_load_dwordx4 v12, s[16:19], s20 offen lds
  s_add_u32 m0, s23, 40960
  s_nop 0
  buffer_load_dwordx4 v5, s[8:11], s21 offen lds
  s_add_u32 m0, s24, 40960
  s_nop 0
  buffer_load_dwordx4 v5, s[8:11], s22 offen lds
  v_add_u32 v5, 0x400, v5
  s_add_u32 s20, s20, 88064
  ds_read_b128 v[192:195], v22 offset:0
  v_mfma_f32_16x16x32_bf16 v[32:35], v[128:131], v[176:179], v[32:35]
  ds_read_b64_tr_b16 v[152:153], v16 offset:0
  v_mfma_f32_16x16x32_bf16 v[36:39], v[128:131], v[180:183], v[36:39]
  ds_read_b64_tr_b16 v[154:155], v16 offset:768
  v_mfma_f32_16x16x32_bf16 v[40:43], v[128:131], v[184:187], v[40:43]
  ds_read_b128 v[196:199], v22 offset:1024
  v_mfma_f32_16x16x32_bf16 v[44:47], v[128:131], v[188:191], v[44:47]
  ds_read_b64_tr_b16 v[156:157], v16 offset:6144
  v_mfma_f32_16x16x32_bf16 v[48:51], v[132:135], v[176:179], v[48:51]
  ds_read_b64_tr_b16 v[158:159], v16 offset:6912
  v_mfma_f32_16x16x32_bf16 v[52:55], v[132:135], v[180:183], v[52:55]
  ds_read_b128 v[200:203], v22 offset:2048
  v_mfma_f32_16x16x32_bf16 v[56:59], v[132:135], v[184:187], v[56:59]
  ds_read_b64_tr_b16 v[160:161], v16 offset:32
  v_mfma_f32_16x16x32_bf16 v[60:63], v[132:135], v[188:191], v[60:63]
  ds_read_b64_tr_b16 v[162:163], v16 offset:800
  v_mfma_f32_16x16x32_bf16 v[64:67], v[136:139], v[176:179], v[64:67]
  ds_read_b128 v[204:207], v22 offset:3072
  v_mfma_f32_16x16x32_bf16 v[68:71], v[136:139], v[180:183], v[68:71]
  ds_read_b64_tr_b16 v[164:165], v16 offset:6176
  v_mfma_f32_16x16x32_bf16 v[72:75], v[136:139], v[184:187], v[72:75]
  ds_read_b64_tr_b16 v[166:167], v16 offset:6944
  v_mfma_f32_16x16x32_bf16 v[76:79], v[136:139], v[188:191], v[76:79]
  ds_read_b64_tr_b16 v[168:169], v16 offset:64
  v_mfma_f32_16x16x32_bf16 v[80:83], v[140:143], v[176:179], v[80:83]
  ds_read_b64_tr_b16 v[170:171], v16 offset:832
  v_mfma_f32_16x16x32_bf16 v[84:87], v[140:143], v[180:183], v[84:87]
  ds_read_b64_tr_b16 v[172:173], v16 offset:6208
  v_mfma_f32_16x16x32_bf16 v[88:91], v[140:143], v[184:187], v[88:91]
  ds_read_b64_tr_b16 v[174:175], v16 offset:6976
  v_mfma_f32_16x16x32_bf16 v[92:95], v[140:143], v[188:191], v[92:95]
  v_mfma_f32_16x16x32_bf16 v[96:99], v[144:147], v[176:179], v[96:99]
  v_mfma_f32_16x16x32_bf16 v[100:103], v[144:147], v[180:183], v[100:103]
  v_mfma_f32_16x16x32_bf16 v[104:107], v[144:147], v[184:187], v[104:107]
  v_mfma_f32_16x16x32_bf16 v[108:111], v[144:147], v[188:191], v[108:111]
  v_mfma_f32_16x16x32_bf16 v[112:115], v[148:151], v[176:179], v[112:115]
  v_mfma_f32_16x16x32_bf16 v[116:119], v[148:151], v[180:183], v[116:119]
  v_mfma_f32_16x16x32_bf16 v[120:123], v[148:151], v[184:187], v[120:123]
  v_mfma_f32_16x16x32_bf16 v[124:127], v[148:151], v[188:191], v[124:127]
  s_waitcnt lgkmcnt(0)
  s_waitcnt vmcnt(5)
  s_barrier
  s_add_u32 m0, s25, 0
  s_nop 0
  buffer_load_dwordx4 v10, s[16:19], s20 offen lds
  s_add_u32 m0, s26, 0
  s_nop 0
  buffer_load_dwordx4 v11, s[16:19], s20 offen lds
  s_add_u32 m0, s27, 0
  s_nop 0
  buffer_load_dwordx4 v12, s[16:19], s20 offen lds
  s_add_u32 m0, s23, 0
  s_nop 0
  buffer_load_dwordx4 v5, s[8:11], s21 offen lds
  s_add_u32 m0, s24, 0
  s_nop 0
  buffer_load_dwordx4 v5, s[8:11], s22 offen lds
  v_add_u32 v5, 0x400, v5
  s_add_u32 s20, s20, 88064
  ds_read_b128 v[176:179], v23 offset:0
  v_mfma_f32_16x16x32_bf16 v[32:35], v[152:155], v[192:195], v[32:35]
  ds_read_b64_tr_b16 v[128:129], v17 offset:0
  v_mfma_f32_16x16x32_bf16 v[36:39], v[152:155], v[196:199], v[36:39]
  ds_read_b64_tr_b16 v[130:131], v17 offset:768
  v_mfma_f32_16x16x32_bf16 v[40:43], v[152:155], v[200:203], v[40:43]
  ds_read_b128 v[180:183], v23 offset:1024
  v_mfma_f32_16x16x32_bf16 v[44:47], v[152:155], v[204:207], v[44:47]
  ds_read_b64_tr_b16 v[132:133], v17 offset:6144
  v_mfma_f32_16x16x32_bf16 v[48:51], v[156:159], v[192:195], v[48:51]
  ds_read_b64_tr_b16 v[134:135], v17 offset:6912
  v_mfma_f32_16x16x32_bf16 v[52:55], v[156:159], v[196:199], v[52:55]
  ds_read_b128 v[184:187], v23 offset:2048
  v_mfma_f32_16x16x32_bf16 v[56:59], v[156:159], v[200:203], v[56:59]
  ds_read_b64_tr_b16 v[136:137], v17 offset:32
  v_mfma_f32_16x16x32_bf16 v[60:63], v[156:159], v[204:207], v[60:63]
  ds_read_b64_tr_b16 v[138:139], v17 offset:800
  v_mfma_f32_16x16x32_bf16 v[64:67], v[160:163], v[192:195], v[64:67]
  ds_read_b128 v[188:191], v23 offset:3072
  v_mfma_f32_16x16x32_bf16 v[68:71], v[160:163], v[196:199], v[68:71]
  ds_read_b64_tr_b16 v[140:141], v17 offset:6176
  v_mfma_f32_16x16x32_bf16 v[72:75], v[160:163], v[200:203], v[72:75]
  ds_read_b64_tr_b16 v[142:143], v17 offset:6944
  v_mfma_f32_16x16x32_bf16 v[76:79], v[160:163], v[204:207], v[76:79]
  ds_read_b64_tr_b16 v[144:145], v17 offset:64
  v_mfma_f32_16x16x32_bf16 v[80:83], v[164:167], v[192:195], v[80:83]
  ds_read_b64_tr_b16 v[146:147], v17 offset:832
  v_mfma_f32_16x16x32_bf16 v[84:87], v[164:167], v[196:199], v[84:87]
  ds_read_b64_tr_b16 v[148:149], v17 offset:6208
  v_mfma_f32_16x16x32_bf16 v[88:91], v[164:167], v[200:203], v[88:91]
  ds_read_b64_tr_b16 v[150:151], v17 offset:6976
  v_mfma_f32_16x16x32_bf16 v[92:95], v[164:167], v[204:207], v[92:95]
  v_mfma_f32_16x16x32_bf16 v[96:99], v[168:171], v[192:195], v[96:99]
  v_mfma_f32_16x16x32_bf16 v[100:103], v[168:171], v[196:199], v[100:103]
  v_mfma_f32_16x16x32_bf16 v[104:107], v[168:171], v[200:203], v[104:107]
  v_mfma_f32_16x16x32_bf16 v[108:111], v[168:171], v[204:207], v[108:111]
  v_mfma_f32_16x16x32_bf16 v[112:115], v[172:175], v[192:195], v[112:115]
  v_mfma_f32_16x16x32_bf16 v[116:119], v[172:175], v[196:199], v[116:119]
  v_mfma_f32_16x16x32_bf16 v[120:123], v[172:175], v[200:203], v[120:123]
  v_mfma_f32_16x16x32_bf16 v[124:127], v[172:175], v[204:207], v[124:127]
  s_waitcnt lgkmcnt(0)
  s_waitcnt vmcnt(5)
  s_barrier
  s_add_u32 m0, s25, 20480
  s_nop 0
  buffer_load_dwordx4 v10, s[16:19], s20 offen lds
  s_add_u32 m0, s26, 20480
  s_nop 0
  buffer_load_dwordx4 v11, s[16:19], s20 offen lds
  s_add_u32 m0, s27, 20480
  s_nop 0
  buffer_load_dwordx4 v12, s[16:19], s20 offen lds
  s_add_u32 m0, s23, 20480
  s_nop 0
  buffer_load_dwordx4 v5, s[8:11], s21 offen lds
  s_add_u32 m0, s24, 20480
  s_nop 0
  buffer_load_dwordx4 v5, s[8:11], s22 offen lds
  v_add_u32 v5, 0x400, v5
  s_add_u32 s20, s20, 88064
  ds_read_b128 v[192:195], v24 offset:0
  v_mfma_f32_16x16x32_bf16 v[32:35], v[128:131], v[176:179], v[32:35]
  ds_read_b64_tr_b16 v[152:153], v18 offset:0
  v_mfma_f32_16x16x32_bf16 v[36:39], v[128:131], v[180:183], v[36:39]
  ds_read_b64_tr_b16 v[154:155], v18 offset:768
  v_mfma_f32_16x16x32_bf16 v[40:43], v[128:131], v[184:187], v[40:43]
  ds_read_b128 v[196:199], v24 offset:1024
  v_mfma_f32_16x16x32_bf16 v[44:47], v[128:131], v[188:191], v[44:47]
  ds_read_b64_tr_b16 v[156:157], v18 offset:6144
  v_mfma_f32_16x16x32_bf16 v[48:51], v[132:135], v[176:179], v[48:51]
  ds_read_b64_tr_b16 v[158:159], v18 offset:6912
  v_mfma_f32_16x16x32_bf16 v[52:55], v[132:135], v[180:183], v[52:55]
  ds_read_b128 v[200:203], v24 offset:2048
  v_mfma_f32_16x16x32_bf16 v[56:59], v[132:135], v[184:187], v[56:59]
  ds_read_b64_tr_b16 v[160:161], v18 offset:32
  v_mfma_f32_16x16x32_bf16 v[60:63], v[132:135], v[188:191], v[60:63]
  ds_read_b64_tr_b16 v[162:163], v18 offset:800
  v_mfma_f32_16x16x32_bf16 v[64:67], v[136:139], v[176:179], v[64:67]
  ds_read_b128 v[204:207], v24 offset:3072
  v_mfma_f32_16x16x32_bf16 v[68:71], v[136:139], v[180:183], v[68:71]
  ds_read_b64_tr_b16 v[164:165], v18 offset:6176
  v_mfma_f32_16x16x32_bf16 v[72:75], v[136:139], v[184:187], v[72:75]
  ds_read_b64_tr_b16 v[166:167], v18 offset:6944
  v_mfma_f32_16x16x32_bf16 v[76:79], v[136:139], v[188:191], v[76:79]
  ds_read_b64_tr_b16 v[168:169], v18 offset:64
  v_mfma_f32_16x16x32_bf16 v[80:83], v[140:143], v[176:179], v[80:83]
  ds_read_b64_tr_b16 v[170:171], v18 offset:832
  v_mfma_f32_16x16x32_bf16 v[84:87], v[140:143], v[180:183], v[84:87]
  ds_read_b64_tr_b16 v[172:173], v18 offset:6208
  v_mfma_f32_16x16x32_bf16 v[88:91], v[140:143], v[184:187], v[88:91]
  ds_read_b64_tr_b16 v[174:175], v18 offset:6976
  v_mfma_f32_16x16x32_bf16 v[92:95], v[140:143], v[188:191], v[92:95]
  v_mfma_f32_16x16x32_bf16 v[96:99], v[144:147], v[176:179], v[96:99]
  v_mfma_f32_16x16x32_bf16 v[100:103], v[144:147], v[180:183], v[100:103]
  v_mfma_f32_16x16x32_bf16 v[104:107], v[144:147], v[184:187], v[104:107]
  v_mfma_f32_16x16x32_bf16 v[108:111], v[144:147], v[188:191], v[108:111]
  v_mfma_f32_16x16x32_bf16 v[112:115], v[148:151], v[176:179], v[112:115]
  v_mfma_f32_16x16x32_bf16 v[116:119], v[148:151], v[180:183], v[116:119]
  v_mfma_f32_16x16x32_bf16 v[120:123], v[148:151], v[184:187], v[120:123]
  v_mfma_f32_16x16x32_bf16 v[124:127], v[148:151], v[188:191], v[124:127]
  s_waitcnt lgkmcnt(0)
  s_waitcnt vmcnt(5)
  s_barrier
  s_add_u32 m0, s25, 40960
  s_nop 0
  buffer_load_dwordx4 v10, s[16:19], s20 offen lds
  s_add_u32 m0, s26, 40960
  s_nop 0
  buffer_load_dwordx4 v11, s[16:19], s20 offen lds
  s_add_u32 m0, s27, 40960
  s_nop 0
  buffer_load_dwordx4 v12, s[16:19], s20 offen lds
  s_add_u32 m0, s23, 40960
  s_nop 0
  buffer_load_dwordx4 v5, s[8:11], s21 offen lds
  s_add_u32 m0, s24, 40960
  s_nop 0
  buffer_load_dwordx4 v5, s[8:11], s22 offen lds
  v_add_u32 v5, 0x400, v5
  s_add_u32 s20, s20, 88064
  ds_read_b128 v[176:179], v22 offset:0
  v_mfma_f32_16x16x32_bf16 v[32:35], v[152:155], v[192:195], v[32:35]
  ds_read_b64_tr_b16 v[128:129], v16 offset:0
  v_mfma_f32_16x16x32_bf16 v[36:39], v[152:155], v[196:199], v[36:39]
  ds_read_b64_tr_b16 v[130:131], v16 offset:768
  v_mfma_f32_16x16x32_bf16 v[40:43], v[152:155], v[200:203], v[40:43]
  ds_read_b128 v[180:183], v22 offset:1024
  v_mfma_f32_16x16x32_bf16 v[44:47], v[152:155], v[204:207], v[44:47]
  ds_read_b64_tr_b16 v[132:133], v16 offset:6144
  v_mfma_f32_16x16x32_bf16 v[48:51], v[156:159], v[192:195], v[48:51]
  ds_read_b64_tr_b16 v[134:135], v16 offset:6912
  v_mfma_f32_16x16x32_bf16 v[52:55], v[156:159], v[196:199], v[52:55]
  ds_read_b128 v[184:187], v22 offset:2048
  v_mfma_f32_16x16x32_bf16 v[56:59], v[156:159], v[200:203], v[56:59]
  ds_read_b64_tr_b16 v[136:137], v16 offset:32
  v_mfma_f32_16x16x32_bf16 v[60:63], v[156:159], v[204:207], v[60:63]
  ds_read_b64_tr_b16 v[138:139], v16 offset:800
  v_mfma_f32_16x16x32_bf16 v[64:67], v[160:163], v[192:195], v[64:67]
  ds_read_b128 v[188:191], v22 offset:3072
  v_mfma_f32_16x16x32_bf16 v[68:71], v[160:163], v[196:199], v[68:71]
  ds_read_b64_tr_b16 v[140:141], v16 offset:6176
  v_mfma_f32_16x16x32_bf16 v[72:75], v[160:163], v[200:203], v[72:75]
  ds_read_b64_tr_b16 v[142:143], v16 offset:6944
  v_mfma_f32_16x16x32_bf16 v[76:79], v[160:163], v[204:207], v[76:79]
  ds_read_b64_tr_b16 v[144:145], v16 offset:64
  v_mfma_f32_16x16x32_bf16 v[80:83], v[164:167], v[192:195], v[80:83]
  ds_read_b64_tr_b16 v[146:147], v16 offset:832
  v_mfma_f32_16x16x32_bf16 v[84:87], v[164:167], v[196:199], v[84:87]
  ds_read_b64_tr_b16 v[148:149], v16 offset:6208
  v_mfma_f32_16x16x32_bf16 v[88:91], v[164:167], v[200:203], v[88:91]
  ds_read_b64_tr_b16 v[150:151], v16 offset:6976
  v_mfma_f32_16x16x32_bf16 v[92:95], v[164:167], v[204:207], v[92:95]
  v_mfma_f32_16x16x32_bf16 v[96:99], v[168:171], v[192:195], v[96:99]
  v_mfma_f32_16x16x32_bf16 v[100:103], v[168:171], v[196:199], v[100:103]
  v_mfma_f32_16x16x32_bf16 v[104:107], v[168:171], v[200:203], v[104:107]
  v_mfma_f32_16x16x32_bf16 v[108:111], v[168:171], v[204:207], v[108:111]
  v_mfma_f32_16x16x32_bf16 v[112:115], v[172:175], v[192:195], v[112:115]
  v_mfma_f32_16x16x32_bf16 v[116:119], v[172:175], v[196:199], v[116:119]
  v_mfma_f32_16x16x32_bf16 v[120:123], v[172:175], v[200:203], v[120:123]
  v_mfma_f32_16x16x32_bf16 v[124:127], v[172:175], v[204:207], v[124:127]
  s_waitcnt lgkmcnt(0)
  s_waitcnt vmcnt(5)
  s_barrier
  s_add_u32 m0, s25, 0
  s_nop 0
  buffer_load_dwordx4 v10, s[16:19], s20 offen lds
  s_add_u32 m0, s26, 0
  s_nop 0
  buffer_load_dwordx4 v11, s[16:19], s20 offen lds
  s_add_u32 m0, s27, 0
  s_nop 0
  buffer_load_dwordx4 v12, s[16:19], s20 offen lds
  s_add_u32 m0, s23, 0
  s_nop 0
  buffer_load_dwordx4 v5, s[8:11], s21 offen lds
  s_add_u32 m0, s24, 0
  s_nop 0
  buffer_load_dwordx4 v5, s[8:11], s22 offen lds
  v_add_u32 v5, 0x400, v5
  s_add_u32 s20, s20, 88064
  ds_read_b128 v[192:195], v23 offset:0
  v_mfma_f32_16x16x32_bf16 v[32:35], v[128:131], v[176:179], v[32:35]
  ds_read_b64_tr_b16 v[152:153], v17 offset:0
  v_mfma_f32_16x16x32_bf16 v[36:39], v[128:131], v[180:183], v[36:39]
  ds_read_b64_tr_b16 v[154:155], v17 offset:768
  v_mfma_f32_16x16x32_bf16 v[40:43], v[128:131], v[184:187], v[40:43]
  ds_read_b128 v[196:199], v23 offset:1024
  v_mfma_f32_16x16x32_bf16 v[44:47], v[128:131], v[188:191], v[44:47]
  ds_read_b64_tr_b16 v[156:157], v17 offset:6144
  v_mfma_f32_16x16x32_bf16 v[48:51], v[132:135], v[176:179], v[48:51]
  ds_read_b64_tr_b16 v[158:159], v17 offset:6912
  v_mfma_f32_16x16x32_bf16 v[52:55], v[132:135], v[180:183], v[52:55]
  ds_read_b128 v[200:203], v23 offset:2048
  v_mfma_f32_16x16x32_bf16 v[56:59], v[132:135], v[184:187], v[56:59]
  ds_read_b64_tr_b16 v[160:161], v17 offset:32
  v_mfma_f32_16x16x32_bf16 v[60:63], v[132:135], v[188:191], v[60:63]
  ds_read_b64_tr_b16 v[162:163], v17 offset:800
  v_mfma_f32_16x16x32_bf16 v[64:67], v[136:139], v[176:179], v[64:67]
  ds_read_b128 v[204:207], v23 offset:3072
  v_mfma_f32_16x16x32_bf16 v[68:71], v[136:139], v[180:183], v[68:71]
  ds_read_b64_tr_b16 v[164:165], v17 offset:6176
  v_mfma_f32_16x16x32_bf16 v[72:75], v[136:139], v[184:187], v[72:75]
  ds_read_b64_tr_b16 v[166:167], v17 offset:6944
  v_mfma_f32_16x16x32_bf16 v[76:79], v[136:139], v[188:191], v[76:79]
  ds_read_b64_tr_b16 v[168:169], v17 offset:64
  v_mfma_f32_16x16x32_bf16 v[80:83], v[140:143], v[176:179], v[80:83]
  ds_read_b64_tr_b16 v[170:171], v17 offset:832
  v_mfma_f32_16x16x32_bf16 v[84:87], v[140:143], v[180:183], v[84:87]
  ds_read_b64_tr_b16 v[172:173], v17 offset:6208
  v_mfma_f32_16x16x32_bf16 v[88:91], v[140:143], v[184:187], v[88:91]
  ds_read_b64_tr_b16 v[174:175], v17 offset:6976
  v_mfma_f32_16x16x32_bf16 v[92:95], v[140:143], v[188:191], v[92:95]
  v_mfma_f32_16x16x32_bf16 v[96:99], v[144:147], v[176:179], v[96:99]
  v_mfma_f32_16x16x32_bf16 v[100:103], v[144:147], v[180:183], v[100:103]
  v_mfma_f32_16x16x32_bf16 v[104:107], v[144:147], v[184:187], v[104:107]
  v_mfma_f32_16x16x32_bf16 v[108:111], v[144:147], v[188:191], v[108:111]
  v_mfma_f32_16x16x32_bf16 v[112:115], v[148:151], v[176:179], v[112:115]
  v_mfma_f32_16x16x32_bf16 v[116:119], v[148:151], v[180:183], v[116:119]
  v_mfma_f32_16x16x32_bf16 v[120:123], v[148:151], v[184:187], v[120:123]
  v_mfma_f32_16x16x32_bf16 v[124:127], v[148:151], v[188:191], v[124:127]
  s_waitcnt lgkmcnt(0)
  s_waitcnt vmcnt(5)
  s_barrier
  s_add_u32 m0, s25, 20480
  s_nop 0
  buffer_load_dwordx4 v10, s[16:19], s20 offen lds
  s_add_u32 m0, s26, 20480
  s_nop 0
  buffer_load_dwordx4 v11, s[16:19], s20 offen lds
  s_add_u32 m0, s27, 20480
  s_nop 0
  buffer_load_dwordx4 v12, s[16:19], s20 offen lds
  s_add_u32 m0, s23, 20480
  s_nop 0
  buffer_load_dwordx4 v5, s[8:11], s21 offen lds
  s_add_u32 m0, s24, 20480
  s_nop 0
  buffer_load_dwordx4 v5, s[8:11], s22 offen lds
  v_add_u32 v5, 0x400, v5
  s_add_u32 s20, s20, 88064
  ds_read_b128 v[176:179], v24 offset:0
  v_mfma_f32_16x16x32_bf16 v[32:35], v[152:155], v[192:195], v[32:35]
  ds_read_b64_tr_b16 v[128:129], v18 offset:0
  v_mfma_f32_16x16x32_bf16 v[36:39], v[152:155], v[196:199], v[36:39]
  ds_read_b64_tr_b16 v[130:131], v18 offset:768
  v_mfma_f32_16x16x32_bf16 v[40:43], v[152:155], v[200:203], v[40:43]
  ds_read_b128 v[180:183], v24 offset:1024
  v_mfma_f32_16x16x32_bf16 v[44:47], v[152:155], v[204:207], v[44:47]
  ds_read_b64_tr_b16 v[132:133], v18 offset:6144
  v_mfma_f32_16x16x32_bf16 v[48:51], v[156:159], v[192:195], v[48:51]
  ds_read_b64_tr_b16 v[134:135], v18 offset:6912
  v_mfma_f32_16x16x32_bf16 v[52:55], v[156:159], v[196:199], v[52:55]
  ds_read_b128 v[184:187], v24 offset:2048
  v_mfma_f32_16x16x32_bf16 v[56:59], v[156:159], v[200:203], v[56:59]
  ds_read_b64_tr_b16 v[136:137], v18 offset:32
  v_mfma_f32_16x16x32_bf16 v[60:63], v[156:159], v[204:207], v[60:63]
  ds_read_b64_tr_b16 v[138:139], v18 offset:800
  v_mfma_f32_16x16x32_bf16 v[64:67], v[160:163], v[192:195], v[64:67]
  ds_read_b128 v[188:191], v24 offset:3072
  v_mfma_f32_16x16x32_bf16 v[68:71], v[160:163], v[196:199], v[68:71]
  ds_read_b64_tr_b16 v[140:141], v18 offset:6176
  v_mfma_f32_16x16x32_bf16 v[72:75], v[160:163], v[200:203], v[72:75]
  ds_read_b64_tr_b16 v[142:143], v18 offset:6944
  v_mfma_f32_16x16x32_bf16 v[76:79], v[160:163], v[204:207], v[76:79]
  ds_read_b64_tr_b16 v[144:145], v18 offset:64
  v_mfma_f32_16x16x32_bf16 v[80:83], v[164:167], v[192:195], v[80:83]
  ds_read_b64_tr_b16 v[146:147], v18 offset:832
  v_mfma_f32_16x16x32_bf16 v[84:87], v[164:167], v[196:199], v[84:87]
  ds_read_b64_tr_b16 v[148:149], v18 offset:6208
  v_mfma_f32_16x16x32_bf16 v[88:91], v[164:167], v[200:203], v[88:91]
  ds_read_b64_tr_b16 v[150:151], v18 offset:6976
  v_mfma_f32_16x16x32_bf16 v[92:95], v[164:167], v[204:207], v[92:95]
  v_mfma_f32_16x16x32_bf16 v[96:99], v[168:171], v[192:195], v[96:99]
  v_mfma_f32_16x16x32_bf16 v[100:103], v[168:171], v[196:199], v[100:103]
  v_mfma_f32_16x16x32_bf16 v[104:107], v[168:171], v[200:203], v[104:107]
  v_mfma_f32_16x16x32_bf16 v[108:111], v[168:171], v[204:207], v[108:111]
  v_mfma_f32_16x16x32_bf16 v[112:115], v[172:175], v[192:195], v[112:115]
  v_mfma_f32_16x16x32_bf16 v[116:119], v[172:175], v[196:199], v[116:119]
  v_mfma_f32_16x16x32_bf16 v[120:123], v[172:175], v[200:203], v[120:123]
  v_mfma_f32_16x16x32_bf16 v[124:127], v[172:175], v[204:207], v[124:127]
  s_waitcnt lgkmcnt(0)
  s_waitcnt vmcnt(5)
  s_barrier
  s_add_u32 m0, s25, 40960
  s_nop 0
  buffer_load_dwordx4 v10, s[16:19], s20 offen lds
  s_add_u32 m0, s26, 40960
  s_nop 0
  buffer_load_dwordx4 v11, s[16:19], s20 offen lds
  s_add_u32 m0, s27, 40960
  s_nop 0
  buffer_load_dwordx4 v12, s[16:19], s20 offen lds
  s_add_u32 m0, s23, 40960
  s_nop 0
  buffer_load_dwordx4 v5, s[8:11], s21 offen lds
  s_add_u32 m0, s24, 40960
  s_nop 0
  buffer_load_dwordx4 v5, s[8:11], s22 offen lds
  v_add_u32 v5, 0x400, v5
  s_add_u32 s20, s20, 88064
  ds_read_b128 v[192:195], v22 offset:0
  v_mfma_f32_16x16x32_bf16 v[32:35], v[128:131], v[176:179], v[32:35]
  ds_read_b64_tr_b16 v[152:153], v16 offset:0
  v_mfma_f32_16x16x32_bf16 v[36:39], v[128:131], v[180:183], v[36:39]
  ds_read_b64_tr_b16 v[154:155], v16 offset:768
  v_mfma_f32_16x16x32_bf16 v[40:43], v[128:131], v[184:187], v[40:43]
  ds_read_b128 v[196:199], v22 offset:1024
  v_mfma_f32_16x16x32_bf16 v[44:47], v[128:131], v[188:191], v[44:47]
  ds_read_b64_tr_b16 v[156:157], v16 offset:6144
  v_mfma_f32_16x16x32_bf16 v[48:51], v[132:135], v[176:179], v[48:51]
  ds_read_b64_tr_b16 v[158:159], v16 offset:6912
  v_mfma_f32_16x16x32_bf16 v[52:55], v[132:135], v[180:183], v[52:55]
  ds_read_b128 v[200:203], v22 offset:2048
  v_mfma_f32_16x16x32_bf16 v[56:59], v[132:135], v[184:187], v[56:59]
  ds_read_b64_tr_b16 v[160:161], v16 offset:32
  v_mfma_f32_16x16x32_bf16 v[60:63], v[132:135], v[188:191], v[60:63]
  ds_read_b64_tr_b16 v[162:163], v16 offset:800
  v_mfma_f32_16x16x32_bf16 v[64:67], v[136:139], v[176:179], v[64:67]
  ds_read_b128 v[204:207], v22 offset:3072
  v_mfma_f32_16x16x32_bf16 v[68:71], v[136:139], v[180:183], v[68:71]
  ds_read_b64_tr_b16 v[164:165], v16 offset:6176
  v_mfma_f32_16x16x32_bf16 v[72:75], v[136:139], v[184:187], v[72:75]
  ds_read_b64_tr_b16 v[166:167], v16 offset:6944
  v_mfma_f32_16x16x32_bf16 v[76:79], v[136:139], v[188:191], v[76:79]
  ds_read_b64_tr_b16 v[168:169], v16 offset:64
  v_mfma_f32_16x16x32_bf16 v[80:83], v[140:143], v[176:179], v[80:83]
  ds_read_b64_tr_b16 v[170:171], v16 offset:832
  v_mfma_f32_16x16x32_bf16 v[84:87], v[140:143], v[180:183], v[84:87]
  ds_read_b64_tr_b16 v[172:173], v16 offset:6208
  v_mfma_f32_16x16x32_bf16 v[88:91], v[140:143], v[184:187], v[88:91]
  ds_read_b64_tr_b16 v[174:175], v16 offset:6976
  v_mfma_f32_16x16x32_bf16 v[92:95], v[140:143], v[188:191], v[92:95]
  v_mfma_f32_16x16x32_bf16 v[96:99], v[144:147], v[176:179], v[96:99]
  v_mfma_f32_16x16x32_bf16 v[100:103], v[144:147], v[180:183], v[100:103]
  v_mfma_f32_16x16x32_bf16 v[104:107], v[144:147], v[184:187], v[104:107]
  v_mfma_f32_16x16x32_bf16 v[108:111], v[144:147], v[188:191], v[108:111]
  v_mfma_f32_16x16x32_bf16 v[112:115], v[148:151], v[176:179], v[112:115]
  v_mfma_f32_16x16x32_bf16 v[116:119], v[148:151], v[180:183], v[116:119]
  v_mfma_f32_16x16x32_bf16 v[120:123], v[148:151], v[184:187], v[120:123]
  v_mfma_f32_16x16x32_bf16 v[124:127], v[148:151], v[188:191], v[124:127]
  s_waitcnt lgkmcnt(0)
  s_waitcnt vmcnt(5)
  s_barrier
  s_add_u32 m0, s25, 0
  s_nop 0
  buffer_load_dwordx4 v10, s[16:19], s20 offen lds
  s_add_u32 m0, s26, 0
  s_nop 0
  buffer_load_dwordx4 v11, s[16:19], s20 offen lds
  s_add_u32 m0, s27, 0
  s_nop 0
  buffer_load_dwordx4 v12, s[16:19], s20 offen lds
  s_add_u32 m0, s23, 0
  s_nop 0
  buffer_load_dwordx4 v5, s[8:11], s21 offen lds
  s_add_u32 m0, s24, 0
  s_nop 0
  buffer_load_dwordx4 v5, s[8:11], s22 offen lds
  v_add_u32 v5, 0x400, v5
  s_add_u32 s20, s20, 88064
  ds_read_b128 v[176:179], v23 offset:0
  v_mfma_f32_16x16x32_bf16 v[32:35], v[152:155], v[192:195], v[32:35]
  ds_read_b64_tr_b16 v[128:129], v17 offset:0
  v_mfma_f32_16x16x32_bf16 v[36:39], v[152:155], v[196:199], v[36:39]
  ds_read_b64_tr_b16 v[130:131], v17 offset:768
  v_mfma_f32_16x16x32_bf16 v[40:43], v[152:155], v[200:203], v[40:43]
  ds_read_b128 v[180:183], v23 offset:1024
  v_mfma_f32_16x16x32_bf16 v[44:47], v[152:155], v[204:207], v[44:47]
  ds_read_b64_tr_b16 v[132:133], v17 offset:6144
  v_mfma_f32_16x16x32_bf16 v[48:51], v[156:159], v[192:195], v[48:51]
  ds_read_b64_tr_b16 v[134:135], v17 offset:6912
  v_mfma_f32_16x16x32_bf16 v[52:55], v[156:159], v[196:199], v[52:55]
  ds_read_b128 v[184:187], v23 offset:2048
  v_mfma_f32_16x16x32_bf16 v[56:59], v[156:159], v[200:203], v[56:59]
  ds_read_b64_tr_b16 v[136:137], v17 offset:32
  v_mfma_f32_16x16x32_bf16 v[60:63], v[156:159], v[204:207], v[60:63]
  ds_read_b64_tr_b16 v[138:139], v17 offset:800
  v_mfma_f32_16x16x32_bf16 v[64:67], v[160:163], v[192:195], v[64:67]
  ds_read_b128 v[188:191], v23 offset:3072
  v_mfma_f32_16x16x32_bf16 v[68:71], v[160:163], v[196:199], v[68:71]
  ds_read_b64_tr_b16 v[140:141], v17 offset:6176
  v_mfma_f32_16x16x32_bf16 v[72:75], v[160:163], v[200:203], v[72:75]
  ds_read_b64_tr_b16 v[142:143], v17 offset:6944
  v_mfma_f32_16x16x32_bf16 v[76:79], v[160:163], v[204:207], v[76:79]
  ds_read_b64_tr_b16 v[144:145], v17 offset:64
  v_mfma_f32_16x16x32_bf16 v[80:83], v[164:167], v[192:195], v[80:83]
  ds_read_b64_tr_b16 v[146:147], v17 offset:832
  v_mfma_f32_16x16x32_bf16 v[84:87], v[164:167], v[196:199], v[84:87]
  ds_read_b64_tr_b16 v[148:149], v17 offset:6208
  v_mfma_f32_16x16x32_bf16 v[88:91], v[164:167], v[200:203], v[88:91]
  ds_read_b64_tr_b16 v[150:151], v17 offset:6976
  v_mfma_f32_16x16x32_bf16 v[92:95], v[164:167], v[204:207], v[92:95]
  v_mfma_f32_16x16x32_bf16 v[96:99], v[168:171], v[192:195], v[96:99]
  v_mfma_f32_16x16x32_bf16 v[100:103], v[168:171], v[196:199], v[100:103]
  v_mfma_f32_16x16x32_bf16 v[104:107], v[168:171], v[200:203], v[104:107]
  v_mfma_f32_16x16x32_bf16 v[108:111], v[168:171], v[204:207], v[108:111]
  v_mfma_f32_16x16x32_bf16 v[112:115], v[172:175], v[192:195], v[112:115]
  v_mfma_f32_16x16x32_bf16 v[116:119], v[172:175], v[196:199], v[116:119]
  v_mfma_f32_16x16x32_bf16 v[120:123], v[172:175], v[200:203], v[120:123]
  v_mfma_f32_16x16x32_bf16 v[124:127], v[172:175], v[204:207], v[124:127]
  s_waitcnt lgkmcnt(0)
  s_waitcnt vmcnt(5)
  s_barrier
  s_add_u32 m0, s25, 20480
  s_nop 0
  buffer_load_dwordx4 v10, s[16:19], s20 offen lds
  s_add_u32 m0, s26, 20480
  s_nop 0
  buffer_load_dwordx4 v11, s[16:19], s20 offen lds
  s_add_u32 m0, s27, 20480
  s_nop 0
  buffer_load_dwordx4 v12, s[16:19], s20 offen lds
  s_add_u32 m0, s23, 20480
  s_nop 0
  buffer_load_dwordx4 v5, s[8:11], s21 offen lds
  s_add_u32 m0, s24, 20480
  s_nop 0
  buffer_load_dwordx4 v5, s[8:11], s22 offen lds
  v_add_u32 v5, 0x400, v5
  s_add_u32 s20, s20, 88064
  ds_read_b128 v[192:195], v24 offset:0
  v_mfma_f32_16x16x32_bf16 v[32:35], v[128:131], v[176:179], v[32:35]
  ds_read_b64_tr_b16 v[152:153], v18 offset:0
  v_mfma_f32_16x16x32_bf16 v[36:39], v[128:131], v[180:183], v[36:39]
  ds_read_b64_tr_b16 v[154:155], v18 offset:768
  v_mfma_f32_16x16x32_bf16 v[40:43], v[128:131], v[184:187], v[40:43]
  ds_read_b128 v[196:199], v24 offset:1024
  v_mfma_f32_16x16x32_bf16 v[44:47], v[128:131], v[188:191], v[44:47]
  ds_read_b64_tr_b16 v[156:157], v18 offset:6144
  v_mfma_f32_16x16x32_bf16 v[48:51], v[132:135], v[176:179], v[48:51]
  ds_read_b64_tr_b16 v[158:159], v18 offset:6912
  v_mfma_f32_16x16x32_bf16 v[52:55], v[132:135], v[180:183], v[52:55]
  ds_read_b128 v[200:203], v24 offset:2048
  v_mfma_f32_16x16x32_bf16 v[56:59], v[132:135], v[184:187], v[56:59]
  ds_read_b64_tr_b16 v[160:161], v18 offset:32
  v_mfma_f32_16x16x32_bf16 v[60:63], v[132:135], v[188:191], v[60:63]
  ds_read_b64_tr_b16 v[162:163], v18 offset:800
  v_mfma_f32_16x16x32_bf16 v[64:67], v[136:139], v[176:179], v[64:67]
  ds_read_b128 v[204:207], v24 offset:3072
  v_mfma_f32_16x16x32_bf16 v[68:71], v[136:139], v[180:183], v[68:71]
  ds_read_b64_tr_b16 v[164:165], v18 offset:6176
  v_mfma_f32_16x16x32_bf16 v[72:75], v[136:139], v[184:187], v[72:75]
  ds_read_b64_tr_b16 v[166:167], v18 offset:6944
  v_mfma_f32_16x16x32_bf16 v[76:79], v[136:139], v[188:191], v[76:79]
  ds_read_b64_tr_b16 v[168:169], v18 offset:64
  v_mfma_f32_16x16x32_bf16 v[80:83], v[140:143], v[176:179], v[80:83]
  ds_read_b64_tr_b16 v[170:171], v18 offset:832
  v_mfma_f32_16x16x32_bf16 v[84:87], v[140:143], v[180:183], v[84:87]
  ds_read_b64_tr_b16 v[172:173], v18 offset:6208
  v_mfma_f32_16x16x32_bf16 v[88:91], v[140:143], v[184:187], v[88:91]
  ds_read_b64_tr_b16 v[174:175], v18 offset:6976
  v_mfma_f32_16x16x32_bf16 v[92:95], v[140:143], v[188:191], v[92:95]
  v_mfma_f32_16x16x32_bf16 v[96:99], v[144:147], v[176:179], v[96:99]
  v_mfma_f32_16x16x32_bf16 v[100:103], v[144:147], v[180:183], v[100:103]
  v_mfma_f32_16x16x32_bf16 v[104:107], v[144:147], v[184:187], v[104:107]
  v_mfma_f32_16x16x32_bf16 v[108:111], v[144:147], v[188:191], v[108:111]
  v_mfma_f32_16x16x32_bf16 v[112:115], v[148:151], v[176:179], v[112:115]
  v_mfma_f32_16x16x32_bf16 v[116:119], v[148:151], v[180:183], v[116:119]
  v_mfma_f32_16x16x32_bf16 v[120:123], v[148:151], v[184:187], v[120:123]
  v_mfma_f32_16x16x32_bf16 v[124:127], v[148:151], v[188:191], v[124:127]
  s_waitcnt lgkmcnt(0)
  s_waitcnt vmcnt(5)
  s_barrier
  s_add_u32 m0, s25, 40960
  s_nop 0
  buffer_load_dwordx4 v10, s[16:19], s20 offen lds
  s_add_u32 m0, s26, 40960
  s_nop 0
  buffer_load_dwordx4 v11, s[16:19], s20 offen lds
  s_add_u32 m0, s27, 40960
  s_nop 0
  buffer_load_dwordx4 v12, s[16:19], s20 offen lds
  s_add_u32 m0, s23, 40960
  s_nop 0
  buffer_load_dwordx4 v5, s[8:11], s21 offen lds
  s_add_u32 m0, s24, 40960
  s_nop 0
  buffer_load_dwordx4 v5, s[8:11], s22 offen lds
  v_add_u32 v5, 0x400, v5
  s_add_u32 s20, s20, 88064
  ds_read_b128 v[176:179], v22 offset:0
  v_mfma_f32_16x16x32_bf16 v[32:35], v[152:155], v[192:195], v[32:35]
  ds_read_b64_tr_b16 v[128:129], v16 offset:0
  v_mfma_f32_16x16x32_bf16 v[36:39], v[152:155], v[196:199], v[36:39]
  ds_read_b64_tr_b16 v[130:131], v16 offset:768
  v_mfma_f32_16x16x32_bf16 v[40:43], v[152:155], v[200:203], v[40:43]
  ds_read_b128 v[180:183], v22 offset:1024
  v_mfma_f32_16x16x32_bf16 v[44:47], v[152:155], v[204:207], v[44:47]
  ds_read_b64_tr_b16 v[132:133], v16 offset:6144
  v_mfma_f32_16x16x32_bf16 v[48:51], v[156:159], v[192:195], v[48:51]
  ds_read_b64_tr_b16 v[134:135], v16 offset:6912
  v_mfma_f32_16x16x32_bf16 v[52:55], v[156:159], v[196:199], v[52:55]
  ds_read_b128 v[184:187], v22 offset:2048
  v_mfma_f32_16x16x32_bf16 v[56:59], v[156:159], v[200:203], v[56:59]
  ds_read_b64_tr_b16 v[136:137], v16 offset:32
  v_mfma_f32_16x16x32_bf16 v[60:63], v[156:159], v[204:207], v[60:63]
  ds_read_b64_tr_b16 v[138:139], v16 offset:800
  v_mfma_f32_16x16x32_bf16 v[64:67], v[160:163], v[192:195], v[64:67]
  ds_read_b128 v[188:191], v22 offset:3072
  v_mfma_f32_16x16x32_bf16 v[68:71], v[160:163], v[196:199], v[68:71]
  ds_read_b64_tr_b16 v[140:141], v16 offset:6176
  v_mfma_f32_16x16x32_bf16 v[72:75], v[160:163], v[200:203], v[72:75]
  ds_read_b64_tr_b16 v[142:143], v16 offset:6944
  v_mfma_f32_16x16x32_bf16 v[76:79], v[160:163], v[204:207], v[76:79]
  ds_read_b64_tr_b16 v[144:145], v16 offset:64
  v_mfma_f32_16x16x32_bf16 v[80:83], v[164:167], v[192:195], v[80:83]
  ds_read_b64_tr_b16 v[146:147], v16 offset:832
  v_mfma_f32_16x16x32_bf16 v[84:87], v[164:167], v[196:199], v[84:87]
  ds_read_b64_tr_b16 v[148:149], v16 offset:6208
  v_mfma_f32_16x16x32_bf16 v[88:91], v[164:167], v[200:203], v[88:91]
  ds_read_b64_tr_b16 v[150:151], v16 offset:6976
  v_mfma_f32_16x16x32_bf16 v[92:95], v[164:167], v[204:207], v[92:95]
  v_mfma_f32_16x16x32_bf16 v[96:99], v[168:171], v[192:195], v[96:99]
  v_mfma_f32_16x16x32_bf16 v[100:103], v[168:171], v[196:199], v[100:103]
  v_mfma_f32_16x16x32_bf16 v[104:107], v[168:171], v[200:203], v[104:107]
  v_mfma_f32_16x16x32_bf16 v[108:111], v[168:171], v[204:207], v[108:111]
  v_mfma_f32_16x16x32_bf16 v[112:115], v[172:175], v[192:195], v[112:115]
  v_mfma_f32_16x16x32_bf16 v[116:119], v[172:175], v[196:199], v[116:119]
  v_mfma_f32_16x16x32_bf16 v[120:123], v[172:175], v[200:203], v[120:123]
  v_mfma_f32_16x16x32_bf16 v[124:127], v[172:175], v[204:207], v[124:127]
  s_waitcnt lgkmcnt(0)
  s_waitcnt vmcnt(5)
  s_barrier
  s_add_u32 m0, s25, 0
  s_nop 0
  buffer_load_dwordx4 v10, s[16:19], s20 offen lds
  s_add_u32 m0, s26, 0
  s_nop 0
  buffer_load_dwordx4 v11, s[16:19], s20 offen lds
  s_add_u32 m0, s27, 0
  s_nop 0
  buffer_load_dwordx4 v12, s[16:19], s20 offen lds
  s_add_u32 m0, s23, 0
  s_nop 0
  buffer_load_dwordx4 v5, s[8:11], s21 offen lds
  s_add_u32 m0, s24, 0
  s_nop 0
  buffer_load_dwordx4 v5, s[8:11], s22 offen lds
  v_add_u32 v5, 0x400, v5
  s_add_u32 s20, s20, 88064
  ds_read_b128 v[192:195], v23 offset:0
  v_mfma_f32_16x16x32_bf16 v[32:35], v[128:131], v[176:179], v[32:35]
  ds_read_b64_tr_b16 v[152:153], v17 offset:0
  v_mfma_f32_16x16x32_bf16 v[36:39], v[128:131], v[180:183], v[36:39]
  ds_read_b64_tr_b16 v[154:155], v17 offset:768
  v_mfma_f32_16x16x32_bf16 v[40:43], v[128:131], v[184:187], v[40:43]
  ds_read_b128 v[196:199], v23 offset:1024
  v_mfma_f32_16x16x32_bf16 v[44:47], v[128:131], v[188:191], v[44:47]
  ds_read_b64_tr_b16 v[156:157], v17 offset:6144
  v_mfma_f32_16x16x32_bf16 v[48:51], v[132:135], v[176:179], v[48:51]
  ds_read_b64_tr_b16 v[158:159], v17 offset:6912
  v_mfma_f32_16x16x32_bf16 v[52:55], v[132:135], v[180:183], v[52:55]
  ds_read_b128 v[200:203], v23 offset:2048
  v_mfma_f32_16x16x32_bf16 v[56:59], v[132:135], v[184:187], v[56:59]
  ds_read_b64_tr_b16 v[160:161], v17 offset:32
  v_mfma_f32_16x16x32_bf16 v[60:63], v[132:135], v[188:191], v[60:63]
  ds_read_b64_tr_b16 v[162:163], v17 offset:800
  v_mfma_f32_16x16x32_bf16 v[64:67], v[136:139], v[176:179], v[64:67]
  ds_read_b128 v[204:207], v23 offset:3072
  v_mfma_f32_16x16x32_bf16 v[68:71], v[136:139], v[180:183], v[68:71]
  ds_read_b64_tr_b16 v[164:165], v17 offset:6176
  v_mfma_f32_16x16x32_bf16 v[72:75], v[136:139], v[184:187], v[72:75]
  ds_read_b64_tr_b16 v[166:167], v17 offset:6944
  v_mfma_f32_16x16x32_bf16 v[76:79], v[136:139], v[188:191], v[76:79]
  ds_read_b64_tr_b16 v[168:169], v17 offset:64
  v_mfma_f32_16x16x32_bf16 v[80:83], v[140:143], v[176:179], v[80:83]
  ds_read_b64_tr_b16 v[170:171], v17 offset:832
  v_mfma_f32_16x16x32_bf16 v[84:87], v[140:143], v[180:183], v[84:87]
  ds_read_b64_tr_b16 v[172:173], v17 offset:6208
  v_mfma_f32_16x16x32_bf16 v[88:91], v[140:143], v[184:187], v[88:91]
  ds_read_b64_tr_b16 v[174:175], v17 offset:6976
  v_mfma_f32_16x16x32_bf16 v[92:95], v[140:143], v[188:191], v[92:95]
  v_mfma_f32_16x16x32_bf16 v[96:99], v[144:147], v[176:179], v[96:99]
  v_mfma_f32_16x16x32_bf16 v[100:103], v[144:147], v[180:183], v[100:103]
  v_mfma_f32_16x16x32_bf16 v[104:107], v[144:147], v[184:187], v[104:107]
  v_mfma_f32_16x16x32_bf16 v[108:111], v[144:147], v[188:191], v[108:111]
  v_mfma_f32_16x16x32_bf16 v[112:115], v[148:151], v[176:179], v[112:115]
  v_mfma_f32_16x16x32_bf16 v[116:119], v[148:151], v[180:183], v[116:119]
  v_mfma_f32_16x16x32_bf16 v[120:123], v[148:151], v[184:187], v[120:123]
  v_mfma_f32_16x16x32_bf16 v[124:127], v[148:151], v[188:191], v[124:127]
  s_waitcnt lgkmcnt(0)
  s_waitcnt vmcnt(5)
  s_barrier
  ds_read_b128 v[176:179], v24 offset:0
  v_mfma_f32_16x16x32_bf16 v[32:35], v[152:155], v[192:195], v[32:35]
  ds_read_b64_tr_b16 v[128:129], v18 offset:0
  v_mfma_f32_16x16x32_bf16 v[36:39], v[152:155], v[196:199], v[36:39]
  ds_read_b64_tr_b16 v[130:131], v18 offset:768
  v_mfma_f32_16x16x32_bf16 v[40:43], v[152:155], v[200:203], v[40:43]
  ds_read_b128 v[180:183], v24 offset:1024
  v_mfma_f32_16x16x32_bf16 v[44:47], v[152:155], v[204:207], v[44:47]
  ds_read_b64_tr_b16 v[132:133], v18 offset:6144
  v_mfma_f32_16x16x32_bf16 v[48:51], v[156:159], v[192:195], v[48:51]
  ds_read_b64_tr_b16 v[134:135], v18 offset:6912
  v_mfma_f32_16x16x32_bf16 v[52:55], v[156:159], v[196:199], v[52:55]
  ds_read_b128 v[184:187], v24 offset:2048
  v_mfma_f32_16x16x32_bf16 v[56:59], v[156:159], v[200:203], v[56:59]
  ds_read_b64_tr_b16 v[136:137], v18 offset:32
  v_mfma_f32_16x16x32_bf16 v[60:63], v[156:159], v[204:207], v[60:63]
  ds_read_b64_tr_b16 v[138:139], v18 offset:800
  v_mfma_f32_16x16x32_bf16 v[64:67], v[160:163], v[192:195], v[64:67]
  ds_read_b128 v[188:191], v24 offset:3072
  v_mfma_f32_16x16x32_bf16 v[68:71], v[160:163], v[196:199], v[68:71]
  ds_read_b64_tr_b16 v[140:141], v18 offset:6176
  v_mfma_f32_16x16x32_bf16 v[72:75], v[160:163], v[200:203], v[72:75]
  ds_read_b64_tr_b16 v[142:143], v18 offset:6944
  v_mfma_f32_16x16x32_bf16 v[76:79], v[160:163], v[204:207], v[76:79]
  ds_read_b64_tr_b16 v[144:145], v18 offset:64
  v_mfma_f32_16x16x32_bf16 v[80:83], v[164:167], v[192:195], v[80:83]
  ds_read_b64_tr_b16 v[146:147], v18 offset:832
  v_mfma_f32_16x16x32_bf16 v[84:87], v[164:167], v[196:199], v[84:87]
  ds_read_b64_tr_b16 v[148:149], v18 offset:6208
  v_mfma_f32_16x16x32_bf16 v[88:91], v[164:167], v[200:203], v[88:91]
  ds_read_b64_tr_b16 v[150:151], v18 offset:6976
  v_mfma_f32_16x16x32_bf16 v[92:95], v[164:167], v[204:207], v[92:95]
  v_mfma_f32_16x16x32_bf16 v[96:99], v[168:171], v[192:195], v[96:99]
  v_mfma_f32_16x16x32_bf16 v[100:103], v[168:171], v[196:199], v[100:103]
  v_mfma_f32_16x16x32_bf16 v[104:107], v[168:171], v[200:203], v[104:107]
  v_mfma_f32_16x16x32_bf16 v[108:111], v[168:171], v[204:207], v[108:111]
  v_mfma_f32_16x16x32_bf16 v[112:115], v[172:175], v[192:195], v[112:115]
  v_mfma_f32_16x16x32_bf16 v[116:119], v[172:175], v[196:199], v[116:119]
  v_mfma_f32_16x16x32_bf16 v[120:123], v[172:175], v[200:203], v[120:123]
  v_mfma_f32_16x16x32_bf16 v[124:127], v[172:175], v[204:207], v[124:127]
  s_waitcnt lgkmcnt(0)
  s_waitcnt vmcnt(0)
  s_barrier
  ds_read_b128 v[192:195], v22 offset:0
  v_mfma_f32_16x16x32_bf16 v[32:35], v[128:131], v[176:179], v[32:35]
  ds_read_b64_tr_b16 v[152:153], v16 offset:0
  v_mfma_f32_16x16x32_bf16 v[36:39], v[128:131], v[180:183], v[36:39]
  ds_read_b64_tr_b16 v[154:155], v16 offset:768
  v_mfma_f32_16x16x32_bf16 v[40:43], v[128:131], v[184:187], v[40:43]
  ds_read_b128 v[196:199], v22 offset:1024
  v_mfma_f32_16x16x32_bf16 v[44:47], v[128:131], v[188:191], v[44:47]
  ds_read_b64_tr_b16 v[156:157], v16 offset:6144
  v_mfma_f32_16x16x32_bf16 v[48:51], v[132:135], v[176:179], v[48:51]
  ds_read_b64_tr_b16 v[158:159], v16 offset:6912
  v_mfma_f32_16x16x32_bf16 v[52:55], v[132:135], v[180:183], v[52:55]
  ds_read_b128 v[200:203], v22 offset:2048
  v_mfma_f32_16x16x32_bf16 v[56:59], v[132:135], v[184:187], v[56:59]
  ds_read_b64_tr_b16 v[160:161], v16 offset:32
  v_mfma_f32_16x16x32_bf16 v[60:63], v[132:135], v[188:191], v[60:63]
  ds_read_b64_tr_b16 v[162:163], v16 offset:800
  v_mfma_f32_16x16x32_bf16 v[64:67], v[136:139], v[176:179], v[64:67]
  ds_read_b128 v[204:207], v22 offset:3072
  v_mfma_f32_16x16x32_bf16 v[68:71], v[136:139], v[180:183], v[68:71]
  ds_read_b64_tr_b16 v[164:165], v16 offset:6176
  v_mfma_f32_16x16x32_bf16 v[72:75], v[136:139], v[184:187], v[72:75]
  ds_read_b64_tr_b16 v[166:167], v16 offset:6944
  v_mfma_f32_16x16x32_bf16 v[76:79], v[136:139], v[188:191], v[76:79]
  ds_read_b64_tr_b16 v[168:169], v16 offset:64
  v_mfma_f32_16x16x32_bf16 v[80:83], v[140:143], v[176:179], v[80:83]
  ds_read_b64_tr_b16 v[170:171], v16 offset:832
  v_mfma_f32_16x16x32_bf16 v[84:87], v[140:143], v[180:183], v[84:87]
  ds_read_b64_tr_b16 v[172:173], v16 offset:6208
  v_mfma_f32_16x16x32_bf16 v[88:91], v[140:143], v[184:187], v[88:91]
  ds_read_b64_tr_b16 v[174:175], v16 offset:6976
  v_mfma_f32_16x16x32_bf16 v[92:95], v[140:143], v[188:191], v[92:95]
  v_mfma_f32_16x16x32_bf16 v[96:99], v[144:147], v[176:179], v[96:99]
  v_mfma_f32_16x16x32_bf16 v[100:103], v[144:147], v[180:183], v[100:103]
  v_mfma_f32_16x16x32_bf16 v[104:107], v[144:147], v[184:187], v[104:107]
  v_mfma_f32_16x16x32_bf16 v[108:111], v[144:147], v[188:191], v[108:111]
  v_mfma_f32_16x16x32_bf16 v[112:115], v[148:151], v[176:179], v[112:115]
  v_mfma_f32_16x16x32_bf16 v[116:119], v[148:151], v[180:183], v[116:119]
  v_mfma_f32_16x16x32_bf16 v[120:123], v[148:151], v[184:187], v[120:123]
  v_mfma_f32_16x16x32_bf16 v[124:127], v[148:151], v[188:191], v[124:127]
  s_waitcnt lgkmcnt(0)
  v_mfma_f32_16x16x32_bf16 v[32:35], v[152:155], v[192:195], v[32:35]
  v_mfma_f32_16x16x32_bf16 v[36:39], v[152:155], v[196:199], v[36:39]
  v_mfma_f32_16x16x32_bf16 v[40:43], v[152:155], v[200:203], v[40:43]
  v_mfma_f32_16x16x32_bf16 v[44:47], v[152:155], v[204:207], v[44:47]
  v_mfma_f32_16x16x32_bf16 v[48:51], v[156:159], v[192:195], v[48:51]
  v_mfma_f32_16x16x32_bf16 v[52:55], v[156:159], v[196:199], v[52:55]
  v_mfma_f32_16x16x32_bf16 v[56:59], v[156:159], v[200:203], v[56:59]
  v_mfma_f32_16x16x32_bf16 v[60:63], v[156:159], v[204:207], v[60:63]
  v_mfma_f32_16x16x32_bf16 v[64:67], v[160:163], v[192:195], v[64:67]
  v_mfma_f32_16x16x32_bf16 v[68:71], v[160:163], v[196:199], v[68:71]
  v_mfma_f32_16x16x32_bf16 v[72:75], v[160:163], v[200:203], v[72:75]
  v_mfma_f32_16x16x32_bf16 v[76:79], v[160:163], v[204:207], v[76:79]
  v_mfma_f32_16x16x32_bf16 v[80:83], v[164:167], v[192:195], v[80:83]
  v_mfma_f32_16x16x32_bf16 v[84:87], v[164:167], v[196:199], v[84:87]
  v_mfma_f32_16x16x32_bf16 v[88:91], v[164:167], v[200:203], v[88:91]
  v_mfma_f32_16x16x32_bf16 v[92:95], v[164:167], v[204:207], v[92:95]
  v_mfma_f32_16x16x32_bf16 v[96:99], v[168:171], v[192:195], v[96:99]
  v_mfma_f32_16x16x32_bf16 v[100:103], v[168:171], v[196:199], v[100:103]
  v_mfma_f32_16x16x32_bf16 v[104:107], v[168:171], v[200:203], v[104:107]
  v_mfma_f32_16x16x32_bf16 v[108:111], v[168:171], v[204:207], v[108:111]
  v_mfma_f32_16x16x32_bf16 v[112:115], v[172:175], v[192:195], v[112:115]
  v_mfma_f32_16x16x32_bf16 v[116:119], v[172:175], v[196:199], v[116:119]
  v_mfma_f32_16x16x32_bf16 v[120:123], v[172:175], v[200:203], v[120:123]
  v_mfma_f32_16x16x32_bf16 v[124:127], v[172:175], v[204:207], v[124:127]
  s_waitcnt lgkmcnt(0)
  s_nop 15
  v_lshrrev_b32 v6, 1, v4
  v_lshlrev_b32 v6, 8, v6
  v_lshl_add_u32 v6, v3, 4, v6
  v_and_b32 v7, 1, v4
  v_lshl_add_u32 v6, v7, 3, v6
  s_lshl_b32 s31, s3, 3
  s_lshl_b32 s32, s33, 2
  s_add_u32 s31, s31, s32
  s_mul_i32 s31, s31, 44032
  s_mul_i32 s32, s34, 3
  s_add_u32 s32, s32, s4
  s_mov_b32 s40, 0xbfb8aa3b
  s_mov_b32 s41, 0xbfb8aa3b
  v_pk_mul_f32 v[20:21], v[32:33], s[40:41]
  v_pk_mul_f32 v[22:23], v[34:35], s[40:41]
  v_exp_f32 v20, v20
  v_exp_f32 v21, v21
  v_exp_f32 v22, v22
  v_exp_f32 v23, v23
  v_pk_mul_f32 v[32:33], v[32:33], v[48:49]
  v_pk_mul_f32 v[34:35], v[34:35], v[50:51]
  v_pk_add_f32 v[20:21], v[20:21], 1.0 op_sel_hi:[1,0]
  v_pk_add_f32 v[22:23], v[22:23], 1.0 op_sel_hi:[1,0]
  v_rcp_f32 v20, v20
  v_rcp_f32 v21, v21
  v_rcp_f32 v22, v22
  v_rcp_f32 v23, v23
  s_add_u32 s36, s32, 0
  s_lshr_b32 s35, s36, 1
  s_lshl_b32 s35, s35, 10
  s_and_b32 s36, s36, 1
  s_lshl_b32 s36, s36, 9
  s_add_u32 s35, s35, s36
  s_add_u32 s35, s35, s31
  s_add_u32 s35, s35, 0
  v_pk_mul_f32 v[32:33], v[32:33], v[20:21]
  v_pk_mul_f32 v[34:35], v[34:35], v[22:23]
  v_cvt_pk_bf16_f32 v32, v32, v33
  v_cvt_pk_bf16_f32 v33, v34, v35
  buffer_store_dwordx2 v[32:33], v6, s[12:15], s35 offen
  v_pk_mul_f32 v[20:21], v[36:37], s[40:41]
  v_pk_mul_f32 v[22:23], v[38:39], s[40:41]
  v_exp_f32 v20, v20
  v_exp_f32 v21, v21
  v_exp_f32 v22, v22
  v_exp_f32 v23, v23
  v_pk_mul_f32 v[36:37], v[36:37], v[52:53]
  v_pk_mul_f32 v[38:39], v[38:39], v[54:55]
  v_pk_add_f32 v[20:21], v[20:21], 1.0 op_sel_hi:[1,0]
  v_pk_add_f32 v[22:23], v[22:23], 1.0 op_sel_hi:[1,0]
  v_rcp_f32 v20, v20
  v_rcp_f32 v21, v21
  v_rcp_f32 v22, v22
  v_rcp_f32 v23, v23
  s_add_u32 s36, s32, 0
  s_lshr_b32 s35, s36, 1
  s_lshl_b32 s35, s35, 10
  s_and_b32 s36, s36, 1
  s_lshl_b32 s36, s36, 9
  s_add_u32 s35, s35, s36
  s_add_u32 s35, s35, s31
  s_add_u32 s35, s35, 44032
  v_pk_mul_f32 v[36:37], v[36:37], v[20:21]
  v_pk_mul_f32 v[38:39], v[38:39], v[22:23]
  v_cvt_pk_bf16_f32 v36, v36, v37
  v_cvt_pk_bf16_f32 v37, v38, v39
  buffer_store_dwordx2 v[36:37], v6, s[12:15], s35 offen
  v_pk_mul_f32 v[20:21], v[40:41], s[40:41]
  v_pk_mul_f32 v[22:23], v[42:43], s[40:41]
  v_exp_f32 v20, v20
  v_exp_f32 v21, v21
  v_exp_f32 v22, v22
  v_exp_f32 v23, v23
  v_pk_mul_f32 v[40:41], v[40:41], v[56:57]
  v_pk_mul_f32 v[42:43], v[42:43], v[58:59]
  v_pk_add_f32 v[20:21], v[20:21], 1.0 op_sel_hi:[1,0]
  v_pk_add_f32 v[22:23], v[22:23], 1.0 op_sel_hi:[1,0]
  v_rcp_f32 v20, v20
  v_rcp_f32 v21, v21
  v_rcp_f32 v22, v22
  v_rcp_f32 v23, v23
  s_add_u32 s36, s32, 0
  s_lshr_b32 s35, s36, 1
  s_lshl_b32 s35, s35, 10
  s_and_b32 s36, s36, 1
  s_lshl_b32 s36, s36, 9
  s_add_u32 s35, s35, s36
  s_add_u32 s35, s35, s31
  s_add_u32 s35, s35, 88064
  v_pk_mul_f32 v[40:41], v[40:41], v[20:21]
  v_pk_mul_f32 v[42:43], v[42:43], v[22:23]
  v_cvt_pk_bf16_f32 v40, v40, v41
  v_cvt_pk_bf16_f32 v41, v42, v43
  buffer_store_dwordx2 v[40:41], v6, s[12:15], s35 offen
  v_pk_mul_f32 v[20:21], v[44:45], s[40:41]
  v_pk_mul_f32 v[22:23], v[46:47], s[40:41]
  v_exp_f32 v20, v20
  v_exp_f32 v21, v21
  v_exp_f32 v22, v22
  v_exp_f32 v23, v23
  v_pk_mul_f32 v[44:45], v[44:45], v[60:61]
  v_pk_mul_f32 v[46:47], v[46:47], v[62:63]
  v_pk_add_f32 v[20:21], v[20:21], 1.0 op_sel_hi:[1,0]
  v_pk_add_f32 v[22:23], v[22:23], 1.0 op_sel_hi:[1,0]
  v_rcp_f32 v20, v20
  v_rcp_f32 v21, v21
  v_rcp_f32 v22, v22
  v_rcp_f32 v23, v23
  s_add_u32 s36, s32, 0
  s_lshr_b32 s35, s36, 1
  s_lshl_b32 s35, s35, 10
  s_and_b32 s36, s36, 1
  s_lshl_b32 s36, s36, 9
  s_add_u32 s35, s35, s36
  s_add_u32 s35, s35, s31
  s_add_u32 s35, s35, 132096
  v_pk_mul_f32 v[44:45], v[44:45], v[20:21]
  v_pk_mul_f32 v[46:47], v[46:47], v[22:23]
  v_cvt_pk_bf16_f32 v44, v44, v45
  v_cvt_pk_bf16_f32 v45, v46, v47
  buffer_store_dwordx2 v[44:45], v6, s[12:15], s35 offen
  v_pk_mul_f32 v[20:21], v[64:65], s[40:41]
  v_pk_mul_f32 v[22:23], v[66:67], s[40:41]
  v_exp_f32 v20, v20
  v_exp_f32 v21, v21
  v_exp_f32 v22, v22
  v_exp_f32 v23, v23
  v_pk_mul_f32 v[64:65], v[64:65], v[80:81]
  v_pk_mul_f32 v[66:67], v[66:67], v[82:83]
  v_pk_add_f32 v[20:21], v[20:21], 1.0 op_sel_hi:[1,0]
  v_pk_add_f32 v[22:23], v[22:23], 1.0 op_sel_hi:[1,0]
  v_rcp_f32 v20, v20
  v_rcp_f32 v21, v21
  v_rcp_f32 v22, v22
  v_rcp_f32 v23, v23
  s_add_u32 s36, s32, 1
  s_lshr_b32 s35, s36, 1
  s_lshl_b32 s35, s35, 10
  s_and_b32 s36, s36, 1
  s_lshl_b32 s36, s36, 9
  s_add_u32 s35, s35, s36
  s_add_u32 s35, s35, s31
  s_add_u32 s35, s35, 0
  v_pk_mul_f32 v[64:65], v[64:65], v[20:21]
  v_pk_mul_f32 v[66:67], v[66:67], v[22:23]
  v_cvt_pk_bf16_f32 v64, v64, v65
  v_cvt_pk_bf16_f32 v65, v66, v67
  buffer_store_dwordx2 v[64:65], v6, s[12:15], s35 offen
  v_pk_mul_f32 v[20:21], v[68:69], s[40:41]
  v_pk_mul_f32 v[22:23], v[70:71], s[40:41]
  v_exp_f32 v20, v20
  v_exp_f32 v21, v21
  v_exp_f32 v22, v22
  v_exp_f32 v23, v23
  v_pk_mul_f32 v[68:69], v[68:69], v[84:85]
  v_pk_mul_f32 v[70:71], v[70:71], v[86:87]
  v_pk_add_f32 v[20:21], v[20:21], 1.0 op_sel_hi:[1,0]
  v_pk_add_f32 v[22:23], v[22:23], 1.0 op_sel_hi:[1,0]
  v_rcp_f32 v20, v20
  v_rcp_f32 v21, v21
  v_rcp_f32 v22, v22
  v_rcp_f32 v23, v23
  s_add_u32 s36, s32, 1
  s_lshr_b32 s35, s36, 1
  s_lshl_b32 s35, s35, 10
  s_and_b32 s36, s36, 1
  s_lshl_b32 s36, s36, 9
  s_add_u32 s35, s35, s36
  s_add_u32 s35, s35, s31
  s_add_u32 s35, s35, 44032
  v_pk_mul_f32 v[68:69], v[68:69], v[20:21]
  v_pk_mul_f32 v[70:71], v[70:71], v[22:23]
  v_cvt_pk_bf16_f32 v68, v68, v69
  v_cvt_pk_bf16_f32 v69, v70, v71
  buffer_store_dwordx2 v[68:69], v6, s[12:15], s35 offen
  v_pk_mul_f32 v[20:21], v[72:73], s[40:41]
  v_pk_mul_f32 v[22:23], v[74:75], s[40:41]
  v_exp_f32 v20, v20
  v_exp_f32 v21, v21
  v_exp_f32 v22, v22
  v_exp_f32 v23, v23
  v_pk_mul_f32 v[72:73], v[72:73], v[88:89]
  v_pk_mul_f32 v[74:75], v[74:75], v[90:91]
  v_pk_add_f32 v[20:21], v[20:21], 1.0 op_sel_hi:[1,0]
  v_pk_add_f32 v[22:23], v[22:23], 1.0 op_sel_hi:[1,0]
  v_rcp_f32 v20, v20
  v_rcp_f32 v21, v21
  v_rcp_f32 v22, v22
  v_rcp_f32 v23, v23
  s_add_u32 s36, s32, 1
  s_lshr_b32 s35, s36, 1
  s_lshl_b32 s35, s35, 10
  s_and_b32 s36, s36, 1
  s_lshl_b32 s36, s36, 9
  s_add_u32 s35, s35, s36
  s_add_u32 s35, s35, s31
  s_add_u32 s35, s35, 88064
  v_pk_mul_f32 v[72:73], v[72:73], v[20:21]
  v_pk_mul_f32 v[74:75], v[74:75], v[22:23]
  v_cvt_pk_bf16_f32 v72, v72, v73
  v_cvt_pk_bf16_f32 v73, v74, v75
  buffer_store_dwordx2 v[72:73], v6, s[12:15], s35 offen
  v_pk_mul_f32 v[20:21], v[76:77], s[40:41]
  v_pk_mul_f32 v[22:23], v[78:79], s[40:41]
  v_exp_f32 v20, v20
  v_exp_f32 v21, v21
  v_exp_f32 v22, v22
  v_exp_f32 v23, v23
  v_pk_mul_f32 v[76:77], v[76:77], v[92:93]
  v_pk_mul_f32 v[78:79], v[78:79], v[94:95]
  v_pk_add_f32 v[20:21], v[20:21], 1.0 op_sel_hi:[1,0]
  v_pk_add_f32 v[22:23], v[22:23], 1.0 op_sel_hi:[1,0]
  v_rcp_f32 v20, v20
  v_rcp_f32 v21, v21
  v_rcp_f32 v22, v22
  v_rcp_f32 v23, v23
  s_add_u32 s36, s32, 1
  s_lshr_b32 s35, s36, 1
  s_lshl_b32 s35, s35, 10
  s_and_b32 s36, s36, 1
  s_lshl_b32 s36, s36, 9
  s_add_u32 s35, s35, s36
  s_add_u32 s35, s35, s31
  s_add_u32 s35, s35, 132096
  v_pk_mul_f32 v[76:77], v[76:77], v[20:21]
  v_pk_mul_f32 v[78:79], v[78:79], v[22:23]
  v_cvt_pk_bf16_f32 v76, v76, v77
  v_cvt_pk_bf16_f32 v77, v78, v79
  buffer_store_dwordx2 v[76:77], v6, s[12:15], s35 offen
  v_pk_mul_f32 v[20:21], v[96:97], s[40:41]
  v_pk_mul_f32 v[22:23], v[98:99], s[40:41]
  v_exp_f32 v20, v20
  v_exp_f32 v21, v21
  v_exp_f32 v22, v22
  v_exp_f32 v23, v23
  v_pk_mul_f32 v[96:97], v[96:97], v[112:113]
  v_pk_mul_f32 v[98:99], v[98:99], v[114:115]
  v_pk_add_f32 v[20:21], v[20:21], 1.0 op_sel_hi:[1,0]
  v_pk_add_f32 v[22:23], v[22:23], 1.0 op_sel_hi:[1,0]
  v_rcp_f32 v20, v20
  v_rcp_f32 v21, v21
  v_rcp_f32 v22, v22
  v_rcp_f32 v23, v23
  s_add_u32 s36, s32, 2
  s_lshr_b32 s35, s36, 1
  s_lshl_b32 s35, s35, 10
  s_and_b32 s36, s36, 1
  s_lshl_b32 s36, s36, 9
  s_add_u32 s35, s35, s36
  s_add_u32 s35, s35, s31
  s_add_u32 s35, s35, 0
  v_pk_mul_f32 v[96:97], v[96:97], v[20:21]
  v_pk_mul_f32 v[98:99], v[98:99], v[22:23]
  v_cvt_pk_bf16_f32 v96, v96, v97
  v_cvt_pk_bf16_f32 v97, v98, v99
  buffer_store_dwordx2 v[96:97], v6, s[12:15], s35 offen
  v_pk_mul_f32 v[20:21], v[100:101], s[40:41]
  v_pk_mul_f32 v[22:23], v[102:103], s[40:41]
  v_exp_f32 v20, v20
  v_exp_f32 v21, v21
  v_exp_f32 v22, v22
  v_exp_f32 v23, v23
  v_pk_mul_f32 v[100:101], v[100:101], v[116:117]
  v_pk_mul_f32 v[102:103], v[102:103], v[118:119]
  v_pk_add_f32 v[20:21], v[20:21], 1.0 op_sel_hi:[1,0]
  v_pk_add_f32 v[22:23], v[22:23], 1.0 op_sel_hi:[1,0]
  v_rcp_f32 v20, v20
  v_rcp_f32 v21, v21
  v_rcp_f32 v22, v22
  v_rcp_f32 v23, v23
  s_add_u32 s36, s32, 2
  s_lshr_b32 s35, s36, 1
  s_lshl_b32 s35, s35, 10
  s_and_b32 s36, s36, 1
  s_lshl_b32 s36, s36, 9
  s_add_u32 s35, s35, s36
  s_add_u32 s35, s35, s31
  s_add_u32 s35, s35, 44032
  v_pk_mul_f32 v[100:101], v[100:101], v[20:21]
  v_pk_mul_f32 v[102:103], v[102:103], v[22:23]
  v_cvt_pk_bf16_f32 v100, v100, v101
  v_cvt_pk_bf16_f32 v101, v102, v103
  buffer_store_dwordx2 v[100:101], v6, s[12:15], s35 offen
  v_pk_mul_f32 v[20:21], v[104:105], s[40:41]
  v_pk_mul_f32 v[22:23], v[106:107], s[40:41]
  v_exp_f32 v20, v20
  v_exp_f32 v21, v21
  v_exp_f32 v22, v22
  v_exp_f32 v23, v23
  v_pk_mul_f32 v[104:105], v[104:105], v[120:121]
  v_pk_mul_f32 v[106:107], v[106:107], v[122:123]
  v_pk_add_f32 v[20:21], v[20:21], 1.0 op_sel_hi:[1,0]
  v_pk_add_f32 v[22:23], v[22:23], 1.0 op_sel_hi:[1,0]
  v_rcp_f32 v20, v20
  v_rcp_f32 v21, v21
  v_rcp_f32 v22, v22
  v_rcp_f32 v23, v23
  s_add_u32 s36, s32, 2
  s_lshr_b32 s35, s36, 1
  s_lshl_b32 s35, s35, 10
  s_and_b32 s36, s36, 1
  s_lshl_b32 s36, s36, 9
  s_add_u32 s35, s35, s36
  s_add_u32 s35, s35, s31
  s_add_u32 s35, s35, 88064
  v_pk_mul_f32 v[104:105], v[104:105], v[20:21]
  v_pk_mul_f32 v[106:107], v[106:107], v[22:23]
  v_cvt_pk_bf16_f32 v104, v104, v105
  v_cvt_pk_bf16_f32 v105, v106, v107
  buffer_store_dwordx2 v[104:105], v6, s[12:15], s35 offen
  v_pk_mul_f32 v[20:21], v[108:109], s[40:41]
  v_pk_mul_f32 v[22:23], v[110:111], s[40:41]
  v_exp_f32 v20, v20
  v_exp_f32 v21, v21
  v_exp_f32 v22, v22
  v_exp_f32 v23, v23
  v_pk_mul_f32 v[108:109], v[108:109], v[124:125]
  v_pk_mul_f32 v[110:111], v[110:111], v[126:127]
  v_pk_add_f32 v[20:21], v[20:21], 1.0 op_sel_hi:[1,0]
  v_pk_add_f32 v[22:23], v[22:23], 1.0 op_sel_hi:[1,0]
  v_rcp_f32 v20, v20
  v_rcp_f32 v21, v21
  v_rcp_f32 v22, v22
  v_rcp_f32 v23, v23
  s_add_u32 s36, s32, 2
  s_lshr_b32 s35, s36, 1
  s_lshl_b32 s35, s35, 10
  s_and_b32 s36, s36, 1
  s_lshl_b32 s36, s36, 9
  s_add_u32 s35, s35, s36
  s_add_u32 s35, s35, s31
  s_add_u32 s35, s35, 132096
  v_pk_mul_f32 v[108:109], v[108:109], v[20:21]
  v_pk_mul_f32 v[110:111], v[110:111], v[22:23]
  v_cvt_pk_bf16_f32 v108, v108, v109
  v_cvt_pk_bf16_f32 v109, v110, v111
  buffer_store_dwordx2 v[108:109], v6, s[12:15], s35 offen
G1_END:
  s_endpgm
MID_CONV:
  s_sub_u32 s2, s2, 240
  s_cmp_ge_u32 s2, 512
  s_cbranch_scc1 CV_END
  s_load_dwordx2 s[40:41], s[0:1], 96
  s_load_dwordx2 s[42:43], s[0:1], 32
  s_load_dwordx2 s[44:45], s[0:1], 40
  s_lshl_b32 s3, s2, 12
  v_lshrrev_b32 v1, 6, v0
  s_nop 0
  v_readfirstlane_b32 s5, v1
  s_waitcnt lgkmcnt(0)
  s_add_u32 s8, s42, s3
  s_addc_u32 s9, s43, 0
  s_and_b32 s9, s9, 0xffff
  s_mov_b32 s10, 0x1000
  s_mov_b32 s11, 0x20000
  s_add_u32 s6, s3, 0x200000
  s_add_u32 s12, s40, s6
  s_addc_u32 s13, s41, 0
  s_and_b32 s13, s13, 0xffff
  s_mov_b32 s14, 0x1000
  s_mov_b32 s15, 0x20000
  s_add_u32 s6, s3, 0xf00000
  s_add_u32 s16, s40, s6
  s_addc_u32 s17, s41, 0
  s_and_b32 s17, s17, 0xffff
  s_mov_b32 s18, 0x1000
  s_mov_b32 s19, 0x20000
  s_mov_b32 s20, s44
  s_mov_b32 s21, s45
  s_and_b32 s21, s21, 0xffff
  s_mov_b32 s22, 0x400
  s_mov_b32 s23, 0x20000
  v_lshlrev_b32 v2, 4, v0
  v_add_u32 v3, 0xffffffc0, v2
  buffer_load_dwordx4 v[8:11], v3, s[8:11], 0 offen
  buffer_load_dwordx4 v[12:15], v3, s[8:11], 0 offen offset:16
  buffer_load_dwordx4 v[16:19], v2, s[12:15], 0 offen
  v_add_u32 v4, 0xfc0, v2
  buffer_load_dwordx4 v[32:35], v4, s[8:11], 0 offen
  buffer_load_dwordx4 v[36:39], v4, s[8:11], 0 offen offset:16
  s_lshl_b32 s7, s2, 1
  v_mov_b32 v5, s7
  buffer_load_ushort v60, v5, s[20:23], 0 offen
  v_lshrrev_b32 v5, 2, v0
  v_mul_u32_u24 v5, 80, v5
  v_and_b32 v6, 3, v0
  v_lshl_add_u32 v5, v6, 4, v5
  v_mov_b32 v28, 0
  v_mov_b32 v29, 0
  v_mov_b32 v30, 0
  v_mov_b32 v31, 0
  v_cmp_gt_u32 vcc, 128, v0
  s_and_saveexec_b64 s[30:31], vcc
  ds_write_b128 v5, v[28:31] offset:33280
  s_mov_b64 exec, s[30:31]
  s_waitcnt vmcnt(4)
  v_alignbit_b32 v20, v9, v8, 16
  v_alignbit_b32 v21, v10, v9, 16
  v_alignbit_b32 v22, v11, v10, 16
  v_alignbit_b32 v23, v12, v11, 16
  v_alignbit_b32 v24, v13, v12, 16
  v_alignbit_b32 v25, v14, v13, 16
  v_alignbit_b32 v26, v15, v14, 16
  ds_write_b128 v2, v[20:23] offset:0
  v_mov_b32 v40, v9
  v_mov_b32 v41, v10
  v_mov_b32 v42, v11
  v_mov_b32 v43, v12
  ds_write_b128 v2, v[40:43] offset:4160
  v_mov_b32 v40, v21
  v_mov_b32 v41, v22
  v_mov_b32 v42, v23
  v_mov_b32 v43, v24
  ds_write_b128 v2, v[40:43] offset:8320
  ds_write_b128 v2, v[10:13] offset:12480
  ds_write_b128 v2, v[22:25] offset:16640
  v_mov_b32 v40, v11
  v_mov_b32 v41, v12
  v_mov_b32 v42, v13
  v_mov_b32 v43, v14
  ds_write_b128 v2, v[40:43] offset:20800
  v_mov_b32 v40, v23
  v_mov_b32 v41, v24
  v_mov_b32 v42, v25
  v_mov_b32 v43, v26
  ds_write_b128 v2, v[40:43] offset:24960
  ds_write_b128 v2, v[12:15] offset:29120
  s_waitcnt vmcnt(3)
  ds_write_b128 v5, v[16:19] offset:35840
  s_waitcnt vmcnt(1)
  v_cmp_gt_u32 vcc, 4, v0
  s_and_saveexec_b64 s[30:31], vcc
  v_alignbit_b32 v20, v33, v32, 16
  v_alignbit_b32 v21, v34, v33, 16
  v_alignbit_b32 v22, v35, v34, 16
  v_alignbit_b32 v23, v36, v35, 16
  v_alignbit_b32 v24, v37, v36, 16
  v_alignbit_b32 v25, v38, v37, 16
  v_alignbit_b32 v26, v39, v38, 16
  ds_write_b128 v2, v[20:23] offset:4096
  v_mov_b32 v40, v33
  v_mov_b32 v41, v34
  v_mov_b32 v42, v35
  v_mov_b32 v43, v36
  ds_write_b128 v2, v[40:43] offset:8256
  v_mov_b32 v40, v21
  v_mov_b32 v41, v22
  v_mov_b32 v42, v23
  v_mov_b32 v43, v24
  ds_write_b128 v2, v[40:43] offset:12416
  ds_write_b128 v2, v[34:37] offset:16576
  ds_write_b128 v2, v[22:25] offset:20736
  v_mov_b32 v40, v35
  v_mov_b32 v41, v36
  v_mov_b32 v42, v37
  v_mov_b32 v43, v38
  ds_write_b128 v2, v[40:43] offset:24896
  v_mov_b32 v40, v23
  v_mov_b32 v41, v24
  v_mov_b32 v42, v25
  v_mov_b32 v43, v26
  ds_write_b128 v2, v[40:43] offset:29056
  ds_write_b128 v2, v[36:39] offset:33216
  s_mov_b64 exec, s[30:31]
  v_and_b32 v1, 63, v0
  v_and_b32 v2, 31, v1
  v_lshrrev_b32 v3, 5, v1
  v_and_b32 v4, 7, v2
  v_mul_u32_u24 v4, 4160, v4
  v_lshrrev_b32 v5, 3, v2
  v_lshl_add_u32 v4, v5, 4, v4
  v_lshlrev_b32 v5, 4, v3
  v_sub_u32 v4, v4, v5
  s_lshl_b32 s6, s5, 6
  s_add_u32 s6, s6, 16
  v_add_u32 v4, s6, v4
  v_mul_u32_u24 v6, 80, v2
  v_add_u32 v6, v6, v5
  s_mul_i32 s6, s5, 80
  s_sub_u32 s6, 31040, s6
  v_add_u32 v6, s6, v6
  s_waitcnt lgkmcnt(0)
  s_barrier
  v_mov_b32 v64, 0
  v_mov_b32 v65, 0
  v_mov_b32 v66, 0
  v_mov_b32 v67, 0
  v_mov_b32 v68, 0
  v_mov_b32 v69, 0
  v_mov_b32 v70, 0
  v_mov_b32 v71, 0
  v_mov_b32 v72, 0
  v_mov_b32 v73, 0
  v_mov_b32 v74, 0
  v_mov_b32 v75, 0
  v_mov_b32 v76, 0
  v_mov_b32 v77, 0
  v_mov_b32 v78, 0
  v_mov_b32 v79, 0
  v_mov_b32 v80, 0
  v_mov_b32 v81, 0
  v_mov_b32 v82, 0
  v_mov_b32 v83, 0
  v_mov_b32 v84, 0
  v_mov_b32 v85, 0
  v_mov_b32 v86, 0
  v_mov_b32 v87, 0
  v_mov_b32 v88, 0
  v_mov_b32 v89, 0
  v_mov_b32 v90, 0
  v_mov_b32 v91, 0
  v_mov_b32 v92, 0
  v_mov_b32 v93, 0
  v_mov_b32 v94, 0
  v_mov_b32 v95, 0
  ds_read_b128 v[96:99], v4 offset:32
  ds_read_b128 v[100:103], v6 offset:7360
  ds_read_b128 v[104:107], v6 offset:4800
  ds_read_b128 v[108:111], v4 offset:0
  ds_read_b128 v[112:115], v6 offset:7392
  ds_read_b128 v[116:119], v6 offset:4832
  ds_read_b128 v[120:123], v4 offset:288
  ds_read_b128 v[124:127], v6 offset:7040
  ds_read_b128 v[128:131], v6 offset:4480
  s_waitcnt lgkmcnt(6)
  v_mfma_f32_32x32x16_bf16 v[80:95], v[96:99], v[100:103], v[80:95]
  v_mfma_f32_32x32x16_bf16 v[64:79], v[96:99], v[104:107], v[64:79]
  ds_read_b128 v[96:99], v4 offset:256
  ds_read_b128 v[100:103], v6 offset:7072
  ds_read_b128 v[104:107], v6 offset:4512
  s_waitcnt lgkmcnt(6)
  v_mfma_f32_32x32x16_bf16 v[80:95], v[108:111], v[112:115], v[80:95]
  v_mfma_f32_32x32x16_bf16 v[64:79], v[108:111], v[116:119], v[64:79]
  ds_read_b128 v[108:111], v4 offset:544
  ds_read_b128 v[112:115], v6 offset:6720
  ds_read_b128 v[116:119], v6 offset:4160
  s_waitcnt lgkmcnt(6)
  v_mfma_f32_32x32x16_bf16 v[80:95], v[120:123], v[124:127], v[80:95]
  v_mfma_f32_32x32x16_bf16 v[64:79], v[120:123], v[128:131], v[64:79]
  ds_read_b128 v[120:123], v4 offset:512
  ds_read_b128 v[124:127], v6 offset:6752
  ds_read_b128 v[128:131], v6 offset:4192
  s_waitcnt lgkmcnt(6)
  v_mfma_f32_32x32x16_bf16 v[80:95], v[96:99], v[100:103], v[80:95]
  v_mfma_f32_32x32x16_bf16 v[64:79], v[96:99], v[104:107], v[64:79]
  ds_read_b128 v[96:99], v4 offset:800
  ds_read_b128 v[100:103], v6 offset:6400
  ds_read_b128 v[104:107], v6 offset:3840
  s_waitcnt lgkmcnt(6)
  v_mfma_f32_32x32x16_bf16 v[80:95], v[108:111], v[112:115], v[80:95]
  v_mfma_f32_32x32x16_bf16 v[64:79], v[108:111], v[116:119], v[64:79]
  ds_read_b128 v[108:111], v4 offset:768
  ds_read_b128 v[112:115], v6 offset:6432
  ds_read_b128 v[116:119], v6 offset:3872
  s_waitcnt lgkmcnt(6)
  v_mfma_f32_32x32x16_bf16 v[80:95], v[120:123], v[124:127], v[80:95]
  v_mfma_f32_32x32x16_bf16 v[64:79], v[120:123], v[128:131], v[64:79]
  ds_read_b128 v[120:123], v4 offset:1056
  ds_read_b128 v[124:127], v6 offset:6080
  ds_read_b128 v[128:131], v6 offset:3520
  s_waitcnt lgkmcnt(6)
  v_mfma_f32_32x32x16_bf16 v[80:95], v[96:99], v[100:103], v[80:95]
  v_mfma_f32_32x32x16_bf16 v[64:79], v[96:99], v[104:107], v[64:79]
  ds_read_b128 v[96:99], v4 offset:1024
  ds_read_b128 v[100:103], v6 offset:6112
  ds_read_b128 v[104:107], v6 offset:3552
  s_waitcnt lgkmcnt(6)
  v_mfma_f32_32x32x16_bf16 v[80:95], v[108:111], v[112:115], v[80:95]
  v_mfma_f32_32x32x16_bf16 v[64:79], v[108:111], v[116:119], v[64:79]
  ds_read_b128 v[108:111], v4 offset:1312
  ds_read_b128 v[112:115], v6 offset:5760
  ds_read_b128 v[116:119], v6 offset:3200
  s_waitcnt lgkmcnt(6)
  v_mfma_f32_32x32x16_bf16 v[80:95], v[120:123], v[124:127], v[80:95]
  v_mfma_f32_32x32x16_bf16 v[64:79], v[120:123], v[128:131], v[64:79]
  ds_read_b128 v[120:123], v4 offset:1280
  ds_read_b128 v[124:127], v6 offset:5792
  ds_read_b128 v[128:131], v6 offset:3232
  s_waitcnt lgkmcnt(6)
  v_mfma_f32_32x32x16_bf16 v[80:95], v[96:99], v[100:103], v[80:95]
  v_mfma_f32_32x32x16_bf16 v[64:79], v[96:99], v[104:107], v[64:79]
  ds_read_b128 v[96:99], v4 offset:1568
  ds_read_b128 v[100:103], v6 offset:5440
  ds_read_b128 v[104:107], v6 offset:2880
  s_waitcnt lgkmcnt(6)
  v_mfma_f32_32x32x16_bf16 v[80:95], v[108:111], v[112:115], v[80:95]
  v_mfma_f32_32x32x16_bf16 v[64:79], v[108:111], v[116:119], v[64:79]
  ds_read_b128 v[108:111], v4 offset:1536
  ds_read_b128 v[112:115], v6 offset:5472
  ds_read_b128 v[116:119], v6 offset:2912
  s_waitcnt lgkmcnt(6)
  v_mfma_f32_32x32x16_bf16 v[80:95], v[120:123], v[124:127], v[80:95]
  v_mfma_f32_32x32x16_bf16 v[64:79], v[120:123], v[128:131], v[64:79]
  ds_read_b128 v[120:123], v4 offset:1824
  ds_read_b128 v[124:127], v6 offset:5120
  ds_read_b128 v[128:131], v6 offset:2560
  s_waitcnt lgkmcnt(6)
  v_mfma_f32_32x32x16_bf16 v[80:95], v[96:99], v[100:103], v[80:95]
  v_mfma_f32_32x32x16_bf16 v[64:79], v[96:99], v[104:107], v[64:79]
  ds_read_b128 v[96:99], v4 offset:1792
  ds_read_b128 v[100:103], v6 offset:5152
  ds_read_b128 v[104:107], v6 offset:2592
  s_waitcnt lgkmcnt(6)
  v_mfma_f32_32x32x16_bf16 v[80:95], v[108:111], v[112:115], v[80:95]
  v_mfma_f32_32x32x16_bf16 v[64:79], v[108:111], v[116:119], v[64:79]
  ds_read_b128 v[108:111], v4 offset:2080
  ds_read_b128 v[112:115], v6 offset:4800
  s_waitcnt lgkmcnt(5)
  v_mfma_f32_32x32x16_bf16 v[80:95], v[120:123], v[124:127], v[80:95]
  v_mfma_f32_32x32x16_bf16 v[64:79], v[120:123], v[128:131], v[64:79]
  ds_read_b128 v[120:123], v4 offset:2048
  ds_read_b128 v[124:127], v6 offset:4832
  s_waitcnt lgkmcnt(4)
  v_mfma_f32_32x32x16_bf16 v[80:95], v[96:99], v[100:103], v[80:95]
  v_mfma_f32_32x32x16_bf16 v[64:79], v[96:99], v[104:107], v[64:79]
  ds_read_b128 v[96:99], v4 offset:2336
  ds_read_b128 v[100:103], v6 offset:4480
  s_waitcnt lgkmcnt(4)
  v_mfma_f32_32x32x16_bf16 v[80:95], v[108:111], v[112:115], v[80:95]
  ds_read_b128 v[108:111], v4 offset:2304
  ds_read_b128 v[112:115], v6 offset:4512
  s_waitcnt lgkmcnt(4)
  v_mfma_f32_32x32x16_bf16 v[80:95], v[120:123], v[124:127], v[80:95]
  ds_read_b128 v[120:123], v4 offset:2592
  ds_read_b128 v[124:127], v6 offset:4160
  s_waitcnt lgkmcnt(4)
  v_mfma_f32_32x32x16_bf16 v[80:95], v[96:99], v[100:103], v[80:95]
  ds_read_b128 v[96:99], v4 offset:2560
  ds_read_b128 v[100:103], v6 offset:4192
  s_waitcnt lgkmcnt(4)
  v_mfma_f32_32x32x16_bf16 v[80:95], v[108:111], v[112:115], v[80:95]
  ds_read_b128 v[108:111], v4 offset:2848
  ds_read_b128 v[112:115], v6 offset:3840
  s_waitcnt lgkmcnt(4)
  v_mfma_f32_32x32x16_bf16 v[80:95], v[120:123], v[124:127], v[80:95]
  ds_read_b128 v[120:123], v4 offset:2816
  ds_read_b128 v[124:127], v6 offset:3872
  s_waitcnt lgkmcnt(4)
  v_mfma_f32_32x32x16_bf16 v[80:95], v[96:99], v[100:103], v[80:95]
  ds_read_b128 v[96:99], v4 offset:3104
  ds_read_b128 v[100:103], v6 offset:3520
  s_waitcnt lgkmcnt(4)
  v_mfma_f32_32x32x16_bf16 v[80:95], v[108:111], v[112:115], v[80:95]
  ds_read_b128 v[108:111], v4 offset:3072
  ds_read_b128 v[112:115], v6 offset:3552
  s_waitcnt lgkmcnt(4)
  v_mfma_f32_32x32x16_bf16 v[80:95], v[120:123], v[124:127], v[80:95]
  ds_read_b128 v[120:123], v4 offset:3360
  ds_read_b128 v[124:127], v6 offset:3200
  s_waitcnt lgkmcnt(4)
  v_mfma_f32_32x32x16_bf16 v[80:95], v[96:99], v[100:103], v[80:95]
  ds_read_b128 v[96:99], v4 offset:3328
  ds_read_b128 v[100:103], v6 offset:3232
  s_waitcnt lgkmcnt(4)
  v_mfma_f32_32x32x16_bf16 v[80:95], v[108:111], v[112:115], v[80:95]
  ds_read_b128 v[108:111], v4 offset:3616
  ds_read_b128 v[112:115], v6 offset:2880
  s_waitcnt lgkmcnt(4)
  v_mfma_f32_32x32x16_bf16 v[80:95], v[120:123], v[124:127], v[80:95]
  ds_read_b128 v[120:123], v4 offset:3584
  ds_read_b128 v[124:127], v6 offset:2912
  s_waitcnt lgkmcnt(4)
  v_mfma_f32_32x32x16_bf16 v[80:95], v[96:99], v[100:103], v[80:95]
  ds_read_b128 v[96:99], v4 offset:3872
  ds_read_b128 v[100:103], v6 offset:2560
  s_waitcnt lgkmcnt(4)
  v_mfma_f32_32x32x16_bf16 v[80:95], v[108:111], v[112:115], v[80:95]
  ds_read_b128 v[108:111], v4 offset:3840
  ds_read_b128 v[112:115], v6 offset:2592
  s_waitcnt lgkmcnt(4)
  v_mfma_f32_32x32x16_bf16 v[80:95], v[120:123], v[124:127], v[80:95]
  s_waitcnt lgkmcnt(2)
  v_mfma_f32_32x32x16_bf16 v[80:95], v[96:99], v[100:103], v[80:95]
  s_waitcnt lgkmcnt(0)
  v_mfma_f32_32x32x16_bf16 v[80:95], v[108:111], v[112:115], v[80:95]
  s_nop 15
  s_nop 3
  s_barrier
  v_lshlrev_b32 v7, 4, v1
  s_lshl_b32 s6, s5, 13
  v_add_u32 v8, s6, v7
  ds_write_b128 v8, v[64:67] offset:0
  ds_write_b128 v8, v[68:71] offset:1024
  ds_write_b128 v8, v[72:75] offset:2048
  ds_write_b128 v8, v[76:79] offset:3072
  ds_write_b128 v8, v[80:83] offset:4096
  ds_write_b128 v8, v[84:87] offset:5120
  ds_write_b128 v8, v[88:91] offset:6144
  ds_write_b128 v8, v[92:95] offset:7168
  s_waitcnt lgkmcnt(0)
  s_barrier
  s_lshl_b32 s6, s5, 11
  v_add_u32 v8, s6, v7
  ds_read_b128 v[96:99], v8 offset:0
  ds_read_b128 v[100:103], v8 offset:8192
  ds_read_b128 v[104:107], v8 offset:16384
  ds_read_b128 v[108:111], v8 offset:24576
  ds_read_b128 v[112:115], v8 offset:1024
  ds_read_b128 v[116:119], v8 offset:9216
  ds_read_b128 v[120:123], v8 offset:17408
  ds_read_b128 v[124:127], v8 offset:25600
  s_lshr_b32 s6, s5, 1
  s_mul_i32 s6, s6, 2560
  s_and_b32 s7, s5, 1
  s_lshl_b32 s7, s7, 5
  s_add_u32 s6, s6, s7
  s_add_u32 s6, s6, 35848
  v_mul_u32_u24 v9, 80, v2
  v_lshlrev_b32 v10, 3, v3
  v_sub_u32 v9, v9, v10
  v_add_u32 v9, s6, v9
  ds_read_b64 v[56:57], v9
  ds_read_b64 v[58:59], v9 offset:16
  s_waitcnt lgkmcnt(0)
  s_waitcnt vmcnt(0)
  v_lshlrev_b32 v60, 16, v60
  s_lshr_b32 s6, s5, 1
  s_lshl_b32 s6, s6, 11
  s_and_b32 s7, s5, 1
  s_lshl_b32 s7, s7, 5
  s_add_u32 s6, s6, s7
  v_lshlrev_b32 v11, 6, v2
  v_lshl_add_u32 v11, v3, 3, v11
  v_add_u32 v11, s6, v11
  v_add_f32 v96, v96, v100
  v_add_f32 v104, v104, v108
  v_add_f32 v96, v96, v104
  v_add_f32 v97, v97, v101
  v_add_f32 v105, v105, v109
  v_add_f32 v97, v97, v105
  v_add_f32 v98, v98, v102
  v_add_f32 v106, v106, v110
  v_add_f32 v98, v98, v106
  v_add_f32 v99, v99, v103
  v_add_f32 v107, v107, v111
  v_add_f32 v99, v99, v107
  v_cvt_pk_bf16_f32 v44, v96, v97
  v_lshlrev_b32 v96, 16, v44
  v_and_b32 v97, 0xffff0000, v44
  v_cvt_pk_bf16_f32 v44, v98, v99
  v_lshlrev_b32 v98, 16, v44
  v_and_b32 v99, 0xffff0000, v44
  v_lshlrev_b32 v48, 16, v56
  v_and_b32 v49, 0xffff0000, v56
  v_lshlrev_b32 v50, 16, v57
  v_and_b32 v51, 0xffff0000, v57
  v_mul_f32 v48, v48, v60
  v_mul_f32 v49, v49, v60
  v_mul_f32 v50, v50, v60
  v_mul_f32 v51, v51, v60
  v_cvt_pk_bf16_f32 v44, v48, v49
  v_lshlrev_b32 v48, 16, v44
  v_and_b32 v49, 0xffff0000, v44
  v_cvt_pk_bf16_f32 v44, v50, v51
  v_lshlrev_b32 v50, 16, v44
  v_and_b32 v51, 0xffff0000, v44
  v_add_f32 v96, v96, v51
  v_add_f32 v97, v97, v50
  v_add_f32 v98, v98, v49
  v_add_f32 v99, v99, v48
  v_cvt_pk_bf16_f32 v52, v96, v97
  v_cvt_pk_bf16_f32 v53, v98, v99
  buffer_store_dwordx2 v[52:53], v11, s[16:19], 0 offen offset:0
  s_nop 0
  v_add_f32 v112, v112, v116
  v_add_f32 v120, v120, v124
  v_add_f32 v112, v112, v120
  v_add_f32 v113, v113, v117
  v_add_f32 v121, v121, v125
  v_add_f32 v113, v113, v121
  v_add_f32 v114, v114, v118
  v_add_f32 v122, v122, v126
  v_add_f32 v114, v114, v122
  v_add_f32 v115, v115, v119
  v_add_f32 v123, v123, v127
  v_add_f32 v115, v115, v123
  v_cvt_pk_bf16_f32 v44, v112, v113
  v_lshlrev_b32 v112, 16, v44
  v_and_b32 v113, 0xffff0000, v44
  v_cvt_pk_bf16_f32 v44, v114, v115
  v_lshlrev_b32 v114, 16, v44
  v_and_b32 v115, 0xffff0000, v44
  v_lshlrev_b32 v48, 16, v58
  v_and_b32 v49, 0xffff0000, v58
  v_lshlrev_b32 v50, 16, v59
  v_and_b32 v51, 0xffff0000, v59
  v_mul_f32 v48, v48, v60
  v_mul_f32 v49, v49, v60
  v_mul_f32 v50, v50, v60
  v_mul_f32 v51, v51, v60
  v_cvt_pk_bf16_f32 v44, v48, v49
  v_lshlrev_b32 v48, 16, v44
  v_and_b32 v49, 0xffff0000, v44
  v_cvt_pk_bf16_f32 v44, v50, v51
  v_lshlrev_b32 v50, 16, v44
  v_and_b32 v51, 0xffff0000, v44
  v_add_f32 v112, v112, v51
  v_add_f32 v113, v113, v50
  v_add_f32 v114, v114, v49
  v_add_f32 v115, v115, v48
  v_cvt_pk_bf16_f32 v52, v112, v113
  v_cvt_pk_bf16_f32 v53, v114, v115
  buffer_store_dwordx2 v[52:53], v11, s[16:19], 0 offen offset:16
  s_nop 0
CV_END:
  s_endpgm
.globl gemm2_kernel
.p2align 8
.type gemm2_kernel,@function
gemm2_kernel:
  s_cmp_ge_u32 s2, 256
  s_cbranch_scc1 G2_END
  s_load_dwordx2 s[40:41], s[0:1], 96
  s_load_dwordx2 s[42:43], s[0:1], 0
  s_load_dwordx2 s[44:45], s[0:1], 80
  s_load_dwordx2 s[46:47], s[0:1], 72
  s_and_b32 s3, s2, 31
  s_lshr_b32 s4, s2, 5
  v_lshrrev_b32 v1, 6, v0
  s_nop 0
  v_readfirstlane_b32 s5, v1
  v_and_b32 v2, 63, v0
  v_and_b32 v3, 15, v2
  v_lshrrev_b32 v4, 4, v2
  s_waitcnt lgkmcnt(0)
  s_add_u32 s8, s40, 0x900000
  s_addc_u32 s9, s41, 0
  s_and_b32 s9, s9, 0xffff
  s_mov_b32 s10, 0x560000
  s_mov_b32 s11, 0x20000
  s_mov_b32 s12, s46
  s_mov_b32 s13, s47
  s_and_b32 s13, s13, 0xffff
  s_mov_b32 s14, 0x158000
  s_mov_b32 s15, 0x20000
  s_add_u32 s16, s40, 0xf00000
  s_addc_u32 s17, s41, 0
  s_and_b32 s17, s17, 0xffff
  s_mov_b32 s18, 0x200000
  s_mov_b32 s19, 0x20000
  s_mov_b32 s20, s40
  s_mov_b32 s21, s41
  s_and_b32 s21, s21, 0xffff
  s_mov_b32 s22, 0x200000
  s_mov_b32 s23, 0x20000
  s_mov_b32 s24, s42
  s_mov_b32 s25, s43
  s_and_b32 s25, s25, 0xffff
  s_mov_b32 s26, 0x200000
  s_mov_b32 s27, 0x20000
  s_mov_b32 s28, s44
  s_mov_b32 s29, s45
  s_and_b32 s29, s29, 0xffff
  s_mov_b32 s30, 0x200000
  s_mov_b32 s31, 0x20000
  s_movk_i32 s34, 2752
  s_lshl_b32 s35, s3, 6
  s_lshl_b32 s36, s4, 6
  v_lshlrev_b32 v7, 4, v2
  s_mul_i32 s38, s3, 176128
  v_add_u32 v5, s38, v7
  s_mul_i32 s37, s5, 11264
  s_mul_i32 s39, s5, 360448
  s_lshl_b32 s38, s36, 1
  s_add_u32 s39, s39, s38
  v_lshrrev_b32 v6, 3, v2
  v_and_b32 v12, 7, v2
  v_lshrrev_b32 v13, 1, v6
  v_and_b32 v13, 1, v13
  v_lshlrev_b32 v13, 1, v13
  v_xor_b32 v12, v12, v13
  v_lshlrev_b32 v6, 10, v6
  v_lshl_add_u32 v6, v12, 4, v6
  v_add_u32 v9, 44032, v5
  v_add_u32 v13, 8192, v6
  v_add_u32 v10, 88064, v5
  v_add_u32 v14, 16384, v6
  v_add_u32 v11, 132096, v5
  v_add_u32 v15, 24576, v6
  v_mov_b32 v8, v5
  v_mov_b32 v12, v6
  v_lshrrev_b32 v16, 2, v0
  v_and_b32 v17, 3, v0
  v_add_u32 v18, s36, v16
  v_lshlrev_b32 v18, 12, v18
  v_lshl_add_u32 v18, v17, 5, v18
  s_lshl_b32 s38, s35, 1
  v_add_u32 v18, s38, v18
  buffer_load_dwordx4 v[20:23], v18, s[16:19], 0 offen
  buffer_load_dwordx4 v[24:27], v18, s[16:19], 0 offen offset:16
  v_mul_u32_u24 v19, 144, v16
  v_lshl_add_u32 v19, v17, 5, v19
  v_lshrrev_b32 v28, 3, v0
  v_and_b32 v29, 7, v0
  v_add_u32 v30, s35, v28
  v_lshlrev_b32 v30, 10, v30
  v_lshl_add_u32 v30, v29, 4, v30
  s_lshl_b32 s38, s36, 1
  v_add_u32 v30, s38, v30
  v_add_u32 v31, s35, v28
  v_lshrrev_b32 v7, 4, v31
  v_lshlrev_b32 v7, 14, v7
  v_and_b32 v31, 15, v31
  v_lshl_add_u32 v7, v31, 4, v7
  v_lshrrev_b32 v31, 2, v29
  s_lshr_b32 s38, s36, 5
  v_add_u32 v31, s38, v31
  v_lshl_add_u32 v7, v31, 10, v7
  v_and_b32 v31, 3, v29
  v_lshl_add_u32 v7, v31, 8, v7
  buffer_load_dwordx4 v[224:227], v30, s[24:27], 0 offen
  buffer_load_dwordx4 v[228:231], v7, s[20:23], 0 offen
  v_add_u32 v30, 0x8000, v30
  v_add_u32 v7, 0x8000, v7
  buffer_load_dwordx4 v[232:235], v30, s[24:27], 0 offen
  buffer_load_dwordx4 v[236:239], v7, s[20:23], 0 offen
  s_mul_i32 s48, s5, 16384
  s_add_u32 s48, s48, 78848
  s_add_u32 m0, s48, 0
  s_nop 0
  buffer_load_dwordx4 v12, s[12:15], s39 offen lds
  s_add_u32 m0, s48, 1024
  s_nop 0
  buffer_load_dwordx4 v13, s[12:15], s39 offen lds
  s_add_u32 m0, s48, 2048
  s_nop 0
  buffer_load_dwordx4 v14, s[12:15], s39 offen lds
  s_add_u32 m0, s48, 3072
  s_nop 0
  buffer_load_dwordx4 v15, s[12:15], s39 offen lds
  buffer_load_dwordx4 v[96:99], v8, s[8:11], s37 offen
  buffer_load_dwordx4 v[100:103], v9, s[8:11], s37 offen
  buffer_load_dwordx4 v[104:107], v10, s[8:11], s37 offen
  buffer_load_dwordx4 v[108:111], v11, s[8:11], s37 offen
  s_add_u32 s37, s37, 1024
  s_add_u32 s39, s39, 32768
  s_add_u32 m0, s48, 4096
  s_nop 0
  buffer_load_dwordx4 v12, s[12:15], s39 offen lds
  s_add_u32 m0, s48, 5120
  s_nop 0
  buffer_load_dwordx4 v13, s[12:15], s39 offen lds
  s_add_u32 m0, s48, 6144
  s_nop 0
  buffer_load_dwordx4 v14, s[12:15], s39 offen lds
  s_add_u32 m0, s48, 7168
  s_nop 0
  buffer_load_dwordx4 v15, s[12:15], s39 offen lds
  buffer_load_dwordx4 v[112:115], v8, s[8:11], s37 offen
  buffer_load_dwordx4 v[116:119], v9, s[8:11], s37 offen
  buffer_load_dwordx4 v[120:123], v10, s[8:11], s37 offen
  buffer_load_dwordx4 v[124:127], v11, s[8:11], s37 offen
  s_add_u32 s37, s37, 1024
  s_add_u32 s39, s39, 32768
  s_add_u32 m0, s48, 8192
  s_nop 0
  buffer_load_dwordx4 v12, s[12:15], s39 offen lds
  s_add_u32 m0, s48, 9216
  s_nop 0
  buffer_load_dwordx4 v13, s[12:15], s39 offen lds
  s_add_u32 m0, s48, 10240
  s_nop 0
  buffer_load_dwordx4 v14, s[12:15], s39 offen lds
  s_add_u32 m0, s48, 11264
  s_nop 0
  buffer_load_dwordx4 v15, s[12:15], s39 offen lds
  buffer_load_dwordx4 v[128:131], v8, s[8:11], s37 offen
  buffer_load_dwordx4 v[132:135], v9, s[8:11], s37 offen
  buffer_load_dwordx4 v[136:139], v10, s[8:11], s37 offen
  buffer_load_dwordx4 v[140:143], v11, s[8:11], s37 offen
  s_add_u32 s37, s37, 1024
  s_add_u32 s39, s39, 32768
  s_add_u32 m0, s48, 12288
  s_nop 0
  buffer_load_dwordx4 v12, s[12:15], s39 offen lds
  s_add_u32 m0, s48, 13312
  s_nop 0
  buffer_load_dwordx4 v13, s[12:15], s39 offen lds
  s_add_u32 m0, s48, 14336
  s_nop 0
  buffer_load_dwordx4 v14, s[12:15], s39 offen lds
  s_add_u32 m0, s48, 15360
  s_nop 0
  buffer_load_dwordx4 v15, s[12:15], s39 offen lds
  buffer_load_dwordx4 v[144:147], v8, s[8:11], s37 offen
  buffer_load_dwordx4 v[148:151], v9, s[8:11], s37 offen
  buffer_load_dwordx4 v[152:155], v10, s[8:11], s37 offen
  buffer_load_dwordx4 v[156:159], v11, s[8:11], s37 offen
  s_add_u32 s37, s37, 1024
  s_add_u32 s39, s39, 32768
  v_mov_b32 v32, 0
  v_mov_b32 v33, 0
  v_mov_b32 v34, 0
  v_mov_b32 v35, 0
  v_mov_b32 v36, 0
  v_mov_b32 v37, 0
  v_mov_b32 v38, 0
  v_mov_b32 v39, 0
  v_mov_b32 v40, 0
  v_mov_b32 v41, 0
  v_mov_b32 v42, 0
  v_mov_b32 v43, 0
  v_mov_b32 v44, 0
  v_mov_b32 v45, 0
  v_mov_b32 v46, 0
  v_mov_b32 v47, 0
  v_mov_b32 v48, 0
  v_mov_b32 v49, 0
  v_mov_b32 v50, 0
  v_mov_b32 v51, 0
  v_mov_b32 v52, 0
  v_mov_b32 v53, 0
  v_mov_b32 v54, 0
  v_mov_b32 v55, 0
  v_mov_b32 v56, 0
  v_mov_b32 v57, 0
  v_mov_b32 v58, 0
  v_mov_b32 v59, 0
  v_mov_b32 v60, 0
  v_mov_b32 v61, 0
  v_mov_b32 v62, 0
  v_mov_b32 v63, 0
  v_mov_b32 v64, 0
  v_mov_b32 v65, 0
  v_mov_b32 v66, 0
  v_mov_b32 v67, 0
  v_mov_b32 v68, 0
  v_mov_b32 v69, 0
  v_mov_b32 v70, 0
  v_mov_b32 v71, 0
  v_mov_b32 v72, 0
  v_mov_b32 v73, 0
  v_mov_b32 v74, 0
  v_mov_b32 v75, 0
  v_mov_b32 v76, 0
  v_mov_b32 v77, 0
  v_mov_b32 v78, 0
  v_mov_b32 v79, 0
  v_mov_b32 v80, 0
  v_mov_b32 v81, 0
  v_mov_b32 v82, 0
  v_mov_b32 v83, 0
  v_mov_b32 v84, 0
  v_mov_b32 v85, 0
  v_mov_b32 v86, 0
  v_mov_b32 v87, 0
  v_mov_b32 v88, 0
  v_mov_b32 v89, 0
  v_mov_b32 v90, 0
  v_mov_b32 v91, 0
  v_mov_b32 v92, 0
  v_mov_b32 v93, 0
  v_mov_b32 v94, 0
  v_mov_b32 v95, 0
  v_lshrrev_b32 v28, 2, v3
  v_and_b32 v29, 3, v3
  v_lshl_add_u32 v31, v4, 3, v28
  v_lshlrev_b32 v31, 7, v31
  v_lshl_add_u32 v31, v29, 3, v31
  v_lshrrev_b32 v28, 1, v28
  v_lshlrev_b32 v28, 5, v28
  v_add_u32 v31, s48, v31
  v_add_u32 v28, v31, v28
  v_xor_b32 v29, 32, v28
  s_waitcnt vmcnt(24)
  ds_read_b64_tr_b16 v[176:177], v28 offset:0
  ds_read_b64_tr_b16 v[178:179], v28 offset:512
  ds_read_b64_tr_b16 v[180:181], v29 offset:0
  ds_read_b64_tr_b16 v[182:183], v29 offset:512
  ds_read_b64_tr_b16 v[184:185], v28 offset:64
  ds_read_b64_tr_b16 v[186:187], v28 offset:576
  ds_read_b64_tr_b16 v[188:189], v29 offset:64
  ds_read_b64_tr_b16 v[190:191], v29 offset:576
  s_waitcnt lgkmcnt(0)
  s_waitcnt vmcnt(16)
  s_add_u32 m0, s48, 0
  s_nop 0
  buffer_load_dwordx4 v12, s[12:15], s39 offen lds
  s_add_u32 m0, s48, 1024
  s_nop 0
  buffer_load_dwordx4 v13, s[12:15], s39 offen lds
  s_add_u32 m0, s48, 2048
  s_nop 0
  buffer_load_dwordx4 v14, s[12:15], s39 offen lds
  s_add_u32 m0, s48, 3072
  s_nop 0
  buffer_load_dwordx4 v15, s[12:15], s39 offen lds
  buffer_load_dwordx4 v[160:163], v8, s[8:11], s37 offen
  buffer_load_dwordx4 v[164:167], v9, s[8:11], s37 offen
  buffer_load_dwordx4 v[168:171], v10, s[8:11], s37 offen
  buffer_load_dwordx4 v[172:175], v11, s[8:11], s37 offen
  s_add_u32 s37, s37, 1024
  s_add_u32 s39, s39, 32768
  ds_read_b64_tr_b16 v[192:193], v28 offset:4096
  v_mfma_f32_16x16x32_bf16 v[32:35], v[176:179], v[96:99], v[32:35]
  v_mfma_f32_16x16x32_bf16 v[36:39], v[176:179], v[100:103], v[36:39]
  ds_read_b64_tr_b16 v[194:195], v28 offset:4608
  v_mfma_f32_16x16x32_bf16 v[40:43], v[176:179], v[104:107], v[40:43]
  v_mfma_f32_16x16x32_bf16 v[44:47], v[176:179], v[108:111], v[44:47]
  ds_read_b64_tr_b16 v[196:197], v29 offset:4096
  v_mfma_f32_16x16x32_bf16 v[48:51], v[180:183], v[96:99], v[48:51]
  v_mfma_f32_16x16x32_bf16 v[52:55], v[180:183], v[100:103], v[52:55]
  ds_read_b64_tr_b16 v[198:199], v29 offset:4608
  v_mfma_f32_16x16x32_bf16 v[56:59], v[180:183], v[104:107], v[56:59]
  v_mfma_f32_16x16x32_bf16 v[60:63], v[180:183], v[108:111], v[60:63]
  ds_read_b64_tr_b16 v[200:201], v28 offset:4160
  v_mfma_f32_16x16x32_bf16 v[64:67], v[184:187], v[96:99], v[64:67]
  v_mfma_f32_16x16x32_bf16 v[68:71], v[184:187], v[100:103], v[68:71]
  ds_read_b64_tr_b16 v[202:203], v28 offset:4672
  v_mfma_f32_16x16x32_bf16 v[72:75], v[184:187], v[104:107], v[72:75]
  v_mfma_f32_16x16x32_bf16 v[76:79], v[184:187], v[108:111], v[76:79]
  ds_read_b64_tr_b16 v[204:205], v29 offset:4160
  v_mfma_f32_16x16x32_bf16 v[80:83], v[188:191], v[96:99], v[80:83]
  v_mfma_f32_16x16x32_bf16 v[84:87], v[188:191], v[100:103], v[84:87]
  ds_read_b64_tr_b16 v[206:207], v29 offset:4672
  v_mfma_f32_16x16x32_bf16 v[88:91], v[188:191], v[104:107], v[88:91]
  v_mfma_f32_16x16x32_bf16 v[92:95], v[188:191], v[108:111], v[92:95]
  s_waitcnt lgkmcnt(0)
  s_waitcnt vmcnt(16)
  s_add_u32 m0, s48, 4096
  s_nop 0
  buffer_load_dwordx4 v12, s[12:15], s39 offen lds
  s_add_u32 m0, s48, 5120
  s_nop 0
  buffer_load_dwordx4 v13, s[12:15], s39 offen lds
  s_add_u32 m0, s48, 6144
  s_nop 0
  buffer_load_dwordx4 v14, s[12:15], s39 offen lds
  s_add_u32 m0, s48, 7168
  s_nop 0
  buffer_load_dwordx4 v15, s[12:15], s39 offen lds
  buffer_load_dwordx4 v[96:99], v8, s[8:11], s37 offen
  buffer_load_dwordx4 v[100:103], v9, s[8:11], s37 offen
  buffer_load_dwordx4 v[104:107], v10, s[8:11], s37 offen
  buffer_load_dwordx4 v[108:111], v11, s[8:11], s37 offen
  s_add_u32 s37, s37, 1024
  s_add_u32 s39, s39, 32768
  ds_read_b64_tr_b16 v[176:177], v28 offset:8192
  v_mfma_f32_16x16x32_bf16 v[32:35], v[192:195], v[112:115], v[32:35]
  v_mfma_f32_16x16x32_bf16 v[36:39], v[192:195], v[116:119], v[36:39]
  ds_read_b64_tr_b16 v[178:179], v28 offset:8704
  v_mfma_f32_16x16x32_bf16 v[40:43], v[192:195], v[120:123], v[40:43]
  v_mfma_f32_16x16x32_bf16 v[44:47], v[192:195], v[124:127], v[44:47]
  ds_read_b64_tr_b16 v[180:181], v29 offset:8192
  v_mfma_f32_16x16x32_bf16 v[48:51], v[196:199], v[112:115], v[48:51]
  v_mfma_f32_16x16x32_bf16 v[52:55], v[196:199], v[116:119], v[52:55]
  ds_read_b64_tr_b16 v[182:183], v29 offset:8704
  v_mfma_f32_16x16x32_bf16 v[56:59], v[196:199], v[120:123], v[56:59]
  v_mfma_f32_16x16x32_bf16 v[60:63], v[196:199], v[124:127], v[60:63]
  ds_read_b64_tr_b16 v[184:185], v28 offset:8256
  v_mfma_f32_16x16x32_bf16 v[64:67], v[200:203], v[112:115], v[64:67]
  v_mfma_f32_16x16x32_bf16 v[68:71], v[200:203], v[116:119], v[68:71]
  ds_read_b64_tr_b16 v[186:187], v28 offset:8768
  v_mfma_f32_16x16x32_bf16 v[72:75], v[200:203], v[120:123], v[72:75]
  v_mfma_f32_16x16x32_bf16 v[76:79], v[200:203], v[124:127], v[76:79]
  ds_read_b64_tr_b16 v[188:189], v29 offset:8256
  v_mfma_f32_16x16x32_bf16 v[80:83], v[204:207], v[112:115], v[80:83]
  v_mfma_f32_16x16x32_bf16 v[84:87], v[204:207], v[116:119], v[84:87]
  ds_read_b64_tr_b16 v[190:191], v29 offset:8768
  v_mfma_f32_16x16x32_bf16 v[88:91], v[204:207], v[120:123], v[88:91]
  v_mfma_f32_16x16x32_bf16 v[92:95], v[204:207], v[124:127], v[92:95]
  s_waitcnt lgkmcnt(0)
  s_waitcnt vmcnt(16)
  s_add_u32 m0, s48, 8192
  s_nop 0
  buffer_load_dwordx4 v12, s[12:15], s39 offen lds
  s_add_u32 m0, s48, 9216
  s_nop 0
  buffer_load_dwordx4 v13, s[12:15], s39 offen lds
  s_add_u32 m0, s48, 10240
  s_nop 0
  buffer_load_dwordx4 v14, s[12:15], s39 offen lds
  s_add_u32 m0, s48, 11264
  s_nop 0
  buffer_load_dwordx4 v15, s[12:15], s39 offen lds
  buffer_load_dwordx4 v[112:115], v8, s[8:11], s37 offen
  buffer_load_dwordx4 v[116:119], v9, s[8:11], s37 offen
  buffer_load_dwordx4 v[120:123], v10, s[8:11], s37 offen
  buffer_load_dwordx4 v[124:127], v11, s[8:11], s37 offen
  s_add_u32 s37, s37, 1024
  s_add_u32 s39, s39, 32768
  ds_read_b64_tr_b16 v[192:193], v28 offset:12288
  v_mfma_f32_16x16x32_bf16 v[32:35], v[176:179], v[128:131], v[32:35]
  v_mfma_f32_16x16x32_bf16 v[36:39], v[176:179], v[132:135], v[36:39]
  ds_read_b64_tr_b16 v[194:195], v28 offset:12800
  v_mfma_f32_16x16x32_bf16 v[40:43], v[176:179], v[136:139], v[40:43]
  v_mfma_f32_16x16x32_bf16 v[44:47], v[176:179], v[140:143], v[44:47]
  ds_read_b64_tr_b16 v[196:197], v29 offset:12288
  v_mfma_f32_16x16x32_bf16 v[48:51], v[180:183], v[128:131], v[48:51]
  v_mfma_f32_16x16x32_bf16 v[52:55], v[180:183], v[132:135], v[52:55]
  ds_read_b64_tr_b16 v[198:199], v29 offset:12800
  v_mfma_f32_16x16x32_bf16 v[56:59], v[180:183], v[136:139], v[56:59]
  v_mfma_f32_16x16x32_bf16 v[60:63], v[180:183], v[140:143], v[60:63]
  ds_read_b64_tr_b16 v[200:201], v28 offset:12352
  v_mfma_f32_16x16x32_bf16 v[64:67], v[184:187], v[128:131], v[64:67]
  v_mfma_f32_16x16x32_bf16 v[68:71], v[184:187], v[132:135], v[68:71]
  ds_read_b64_tr_b16 v[202:203], v28 offset:12864
  v_mfma_f32_16x16x32_bf16 v[72:75], v[184:187], v[136:139], v[72:75]
  v_mfma_f32_16x16x32_bf16 v[76:79], v[184:187], v[140:143], v[76:79]
  ds_read_b64_tr_b16 v[204:205], v29 offset:12352
  v_mfma_f32_16x16x32_bf16 v[80:83], v[188:191], v[128:131], v[80:83]
  v_mfma_f32_16x16x32_bf16 v[84:87], v[188:191], v[132:135], v[84:87]
  ds_read_b64_tr_b16 v[206:207], v29 offset:12864
  v_mfma_f32_16x16x32_bf16 v[88:91], v[188:191], v[136:139], v[88:91]
  v_mfma_f32_16x16x32_bf16 v[92:95], v[188:191], v[140:143], v[92:95]
  s_waitcnt lgkmcnt(0)
  s_waitcnt vmcnt(16)
  s_add_u32 m0, s48, 12288
  s_nop 0
  buffer_load_dwordx4 v12, s[12:15], s39 offen lds
  s_add_u32 m0, s48, 13312
  s_nop 0
  buffer_load_dwordx4 v13, s[12:15], s39 offen lds
  s_add_u32 m0, s48, 14336
  s_nop 0
  buffer_load_dwordx4 v14, s[12:15], s39 offen lds
  s_add_u32 m0, s48, 15360
  s_nop 0
  buffer_load_dwordx4 v15, s[12:15], s39 offen lds
  buffer_load_dwordx4 v[128:131], v8, s[8:11], s37 offen
  buffer_load_dwordx4 v[132:135], v9, s[8:11], s37 offen
  buffer_load_dwordx4 v[136:139], v10, s[8:11], s37 offen
  buffer_load_dwordx4 v[140:143], v11, s[8:11], s37 offen
  s_add_u32 s37, s37, 1024
  s_add_u32 s39, s39, 32768
  ds_read_b64_tr_b16 v[176:177], v28 offset:0
  v_mfma_f32_16x16x32_bf16 v[32:35], v[192:195], v[144:147], v[32:35]
  v_mfma_f32_16x16x32_bf16 v[36:39], v[192:195], v[148:151], v[36:39]
  ds_read_b64_tr_b16 v[178:179], v28 offset:512
  v_mfma_f32_16x16x32_bf16 v[40:43], v[192:195], v[152:155], v[40:43]
  v_mfma_f32_16x16x32_bf16 v[44:47], v[192:195], v[156:159], v[44:47]
  ds_read_b64_tr_b16 v[180:181], v29 offset:0
  v_mfma_f32_16x16x32_bf16 v[48:51], v[196:199], v[144:147], v[48:51]
  v_mfma_f32_16x16x32_bf16 v[52:55], v[196:199], v[148:151], v[52:55]
  ds_read_b64_tr_b16 v[182:183], v29 offset:512
  v_mfma_f32_16x16x32_bf16 v[56:59], v[196:199], v[152:155], v[56:59]
  v_mfma_f32_16x16x32_bf16 v[60:63], v[196:199], v[156:159], v[60:63]
  ds_read_b64_tr_b16 v[184:185], v28 offset:64
  v_mfma_f32_16x16x32_bf16 v[64:67], v[200:203], v[144:147], v[64:67]
  v_mfma_f32_16x16x32_bf16 v[68:71], v[200:203], v[148:151], v[68:71]
  ds_read_b64_tr_b16 v[186:187], v28 offset:576
  v_mfma_f32_16x16x32_bf16 v[72:75], v[200:203], v[152:155], v[72:75]
  v_mfma_f32_16x16x32_bf16 v[76:79], v[200:203], v[156:159], v[76:79]
  ds_read_b64_tr_b16 v[188:189], v29 offset:64
  v_mfma_f32_16x16x32_bf16 v[80:83], v[204:207], v[144:147], v[80:83]
  v_mfma_f32_16x16x32_bf16 v[84:87], v[204:207], v[148:151], v[84:87]
  ds_read_b64_tr_b16 v[190:191], v29 offset:576
  v_mfma_f32_16x16x32_bf16 v[88:91], v[204:207], v[152:155], v[88:91]
  v_mfma_f32_16x16x32_bf16 v[92:95], v[204:207], v[156:159], v[92:95]
  s_waitcnt lgkmcnt(0)
  s_waitcnt vmcnt(16)
  s_add_u32 m0, s48, 0
  s_nop 0
  buffer_load_dwordx4 v12, s[12:15], s39 offen lds
  s_add_u32 m0, s48, 1024
  s_nop 0
  buffer_load_dwordx4 v13, s[12:15], s39 offen lds
  s_add_u32 m0, s48, 2048
  s_nop 0
  buffer_load_dwordx4 v14, s[12:15], s39 offen lds
  s_add_u32 m0, s48, 3072
  s_nop 0
  buffer_load_dwordx4 v15, s[12:15], s39 offen lds
  buffer_load_dwordx4 v[144:147], v8, s[8:11], s37 offen
  buffer_load_dwordx4 v[148:151], v9, s[8:11], s37 offen
  buffer_load_dwordx4 v[152:155], v10, s[8:11], s37 offen
  buffer_load_dwordx4 v[156:159], v11, s[8:11], s37 offen
  s_add_u32 s37, s37, 1024
  s_add_u32 s39, s39, 32768
  ds_read_b64_tr_b16 v[192:193], v28 offset:4096
  v_mfma_f32_16x16x32_bf16 v[32:35], v[176:179], v[160:163], v[32:35]
  v_mfma_f32_16x16x32_bf16 v[36:39], v[176:179], v[164:167], v[36:39]
  ds_read_b64_tr_b16 v[194:195], v28 offset:4608
  v_mfma_f32_16x16x32_bf16 v[40:43], v[176:179], v[168:171], v[40:43]
  v_mfma_f32_16x16x32_bf16 v[44:47], v[176:179], v[172:175], v[44:47]
  ds_read_b64_tr_b16 v[196:197], v29 offset:4096
  v_mfma_f32_16x16x32_bf16 v[48:51], v[180:183], v[160:163], v[48:51]
  v_mfma_f32_16x16x32_bf16 v[52:55], v[180:183], v[164:167], v[52:55]
  ds_read_b64_tr_b16 v[198:199], v29 offset:4608
  v_mfma_f32_16x16x32_bf16 v[56:59], v[180:183], v[168:171], v[56:59]
  v_mfma_f32_16x16x32_bf16 v[60:63], v[180:183], v[172:175], v[60:63]
  ds_read_b64_tr_b16 v[200:201], v28 offset:4160
  v_mfma_f32_16x16x32_bf16 v[64:67], v[184:187], v[160:163], v[64:67]
  v_mfma_f32_16x16x32_bf16 v[68:71], v[184:187], v[164:167], v[68:71]
  ds_read_b64_tr_b16 v[202:203], v28 offset:4672
  v_mfma_f32_16x16x32_bf16 v[72:75], v[184:187], v[168:171], v[72:75]
  v_mfma_f32_16x16x32_bf16 v[76:79], v[184:187], v[172:175], v[76:79]
  ds_read_b64_tr_b16 v[204:205], v29 offset:4160
  v_mfma_f32_16x16x32_bf16 v[80:83], v[188:191], v[160:163], v[80:83]
  v_mfma_f32_16x16x32_bf16 v[84:87], v[188:191], v[164:167], v[84:87]
  ds_read_b64_tr_b16 v[206:207], v29 offset:4672
  v_mfma_f32_16x16x32_bf16 v[88:91], v[188:191], v[168:171], v[88:91]
  v_mfma_f32_16x16x32_bf16 v[92:95], v[188:191], v[172:175], v[92:95]
  s_waitcnt lgkmcnt(0)
  s_waitcnt vmcnt(16)
  s_add_u32 m0, s48, 4096
  s_nop 0
  buffer_load_dwordx4 v12, s[12:15], s39 offen lds
  s_add_u32 m0, s48, 5120
  s_nop 0
  buffer_load_dwordx4 v13, s[12:15], s39 offen lds
  s_add_u32 m0, s48, 6144
  s_nop 0
  buffer_load_dwordx4 v14, s[12:15], s39 offen lds
  s_add_u32 m0, s48, 7168
  s_nop 0
  buffer_load_dwordx4 v15, s[12:15], s39 offen lds
  buffer_load_dwordx4 v[160:163], v8, s[8:11], s37 offen
  buffer_load_dwordx4 v[164:167], v9, s[8:11], s37 offen
  buffer_load_dwordx4 v[168:171], v10, s[8:11], s37 offen
  buffer_load_dwordx4 v[172:175], v11, s[8:11], s37 offen
  s_add_u32 s37, s37, 1024
  s_add_u32 s39, s39, 32768
  ds_read_b64_tr_b16 v[176:177], v28 offset:8192
  v_mfma_f32_16x16x32_bf16 v[32:35], v[192:195], v[96:99], v[32:35]
  v_mfma_f32_16x16x32_bf16 v[36:39], v[192:195], v[100:103], v[36:39]
  ds_read_b64_tr_b16 v[178:179], v28 offset:8704
  v_mfma_f32_16x16x32_bf16 v[40:43], v[192:195], v[104:107], v[40:43]
  v_mfma_f32_16x16x32_bf16 v[44:47], v[192:195], v[108:111], v[44:47]
  ds_read_b64_tr_b16 v[180:181], v29 offset:8192
  v_mfma_f32_16x16x32_bf16 v[48:51], v[196:199], v[96:99], v[48:51]
  v_mfma_f32_16x16x32_bf16 v[52:55], v[196:199], v[100:103], v[52:55]
  ds_read_b64_tr_b16 v[182:183], v29 offset:8704
  v_mfma_f32_16x16x32_bf16 v[56:59], v[196:199], v[104:107], v[56:59]
  v_mfma_f32_16x16x32_bf16 v[60:63], v[196:199], v[108:111], v[60:63]
  ds_read_b64_tr_b16 v[184:185], v28 offset:8256
  v_mfma_f32_16x16x32_bf16 v[64:67], v[200:203], v[96:99], v[64:67]
  v_mfma_f32_16x16x32_bf16 v[68:71], v[200:203], v[100:103], v[68:71]
  ds_read_b64_tr_b16 v[186:187], v28 offset:8768
  v_mfma_f32_16x16x32_bf16 v[72:75], v[200:203], v[104:107], v[72:75]
  v_mfma_f32_16x16x32_bf16 v[76:79], v[200:203], v[108:111], v[76:79]
  ds_read_b64_tr_b16 v[188:189], v29 offset:8256
  v_mfma_f32_16x16x32_bf16 v[80:83], v[204:207], v[96:99], v[80:83]
  v_mfma_f32_16x16x32_bf16 v[84:87], v[204:207], v[100:103], v[84:87]
  ds_read_b64_tr_b16 v[190:191], v29 offset:8768
  v_mfma_f32_16x16x32_bf16 v[88:91], v[204:207], v[104:107], v[88:91]
  v_mfma_f32_16x16x32_bf16 v[92:95], v[204:207], v[108:111], v[92:95]
  s_waitcnt lgkmcnt(0)
  s_waitcnt vmcnt(16)
  s_add_u32 m0, s48, 8192
  s_nop 0
  buffer_load_dwordx4 v12, s[12:15], s39 offen lds
  s_add_u32 m0, s48, 9216
  s_nop 0
  buffer_load_dwordx4 v13, s[12:15], s39 offen lds
  s_add_u32 m0, s48, 10240
  s_nop 0
  buffer_load_dwordx4 v14, s[12:15], s39 offen lds
  s_add_u32 m0, s48, 11264
  s_nop 0
  buffer_load_dwordx4 v15, s[12:15], s39 offen lds
  buffer_load_dwordx4 v[96:99], v8, s[8:11], s37 offen
  buffer_load_dwordx4 v[100:103], v9, s[8:11], s37 offen
  buffer_load_dwordx4 v[104:107], v10, s[8:11], s37 offen
  buffer_load_dwordx4 v[108:111], v11, s[8:11], s37 offen
  s_add_u32 s37, s37, 1024
  s_add_u32 s39, s39, 32768
  ds_read_b64_tr_b16 v[192:193], v28 offset:12288
  v_mfma_f32_16x16x32_bf16 v[32:35], v[176:179], v[112:115], v[32:35]
  v_mfma_f32_16x16x32_bf16 v[36:39], v[176:179], v[116:119], v[36:39]
  ds_read_b64_tr_b16 v[194:195], v28 offset:12800
  v_mfma_f32_16x16x32_bf16 v[40:43], v[176:179], v[120:123], v[40:43]
  v_mfma_f32_16x16x32_bf16 v[44:47], v[176:179], v[124:127], v[44:47]
  ds_read_b64_tr_b16 v[196:197], v29 offset:12288
  v_mfma_f32_16x16x32_bf16 v[48:51], v[180:183], v[112:115], v[48:51]
  v_mfma_f32_16x16x32_bf16 v[52:55], v[180:183], v[116:119], v[52:55]
  ds_read_b64_tr_b16 v[198:199], v29 offset:12800
  v_mfma_f32_16x16x32_bf16 v[56:59], v[180:183], v[120:123], v[56:59]
  v_mfma_f32_16x16x32_bf16 v[60:63], v[180:183], v[124:127], v[60:63]
  ds_read_b64_tr_b16 v[200:201], v28 offset:12352
  v_mfma_f32_16x16x32_bf16 v[64:67], v[184:187], v[112:115], v[64:67]
  v_mfma_f32_16x16x32_bf16 v[68:71], v[184:187], v[116:119], v[68:71]
  ds_read_b64_tr_b16 v[202:203], v28 offset:12864
  v_mfma_f32_16x16x32_bf16 v[72:75], v[184:187], v[120:123], v[72:75]
  v_mfma_f32_16x16x32_bf16 v[76:79], v[184:187], v[124:127], v[76:79]
  ds_read_b64_tr_b16 v[204:205], v29 offset:12352
  v_mfma_f32_16x16x32_bf16 v[80:83], v[188:191], v[112:115], v[80:83]
  v_mfma_f32_16x16x32_bf16 v[84:87], v[188:191], v[116:119], v[84:87]
  ds_read_b64_tr_b16 v[206:207], v29 offset:12864
  v_mfma_f32_16x16x32_bf16 v[88:91], v[188:191], v[120:123], v[88:91]
  v_mfma_f32_16x16x32_bf16 v[92:95], v[188:191], v[124:127], v[92:95]
  s_waitcnt lgkmcnt(0)
  s_waitcnt vmcnt(16)
  ds_read_b64_tr_b16 v[176:177], v28 offset:0
  v_mfma_f32_16x16x32_bf16 v[32:35], v[192:195], v[128:131], v[32:35]
  v_mfma_f32_16x16x32_bf16 v[36:39], v[192:195], v[132:135], v[36:39]
  ds_read_b64_tr_b16 v[178:179], v28 offset:512
  v_mfma_f32_16x16x32_bf16 v[40:43], v[192:195], v[136:139], v[40:43]
  v_mfma_f32_16x16x32_bf16 v[44:47], v[192:195], v[140:143], v[44:47]
  ds_read_b64_tr_b16 v[180:181], v29 offset:0
  v_mfma_f32_16x16x32_bf16 v[48:51], v[196:199], v[128:131], v[48:51]
  v_mfma_f32_16x16x32_bf16 v[52:55], v[196:199], v[132:135], v[52:55]
  ds_read_b64_tr_b16 v[182:183], v29 offset:512
  v_mfma_f32_16x16x32_bf16 v[56:59], v[196:199], v[136:139], v[56:59]
  v_mfma_f32_16x16x32_bf16 v[60:63], v[196:199], v[140:143], v[60:63]
  ds_read_b64_tr_b16 v[184:185], v28 offset:64
  v_mfma_f32_16x16x32_bf16 v[64:67], v[200:203], v[128:131], v[64:67]
  v_mfma_f32_16x16x32_bf16 v[68:71], v[200:203], v[132:135], v[68:71]
  ds_read_b64_tr_b16 v[186:187], v28 offset:576
  v_mfma_f32_16x16x32_bf16 v[72:75], v[200:203], v[136:139], v[72:75]
  v_mfma_f32_16x16x32_bf16 v[76:79], v[200:203], v[140:143], v[76:79]
  ds_read_b64_tr_b16 v[188:189], v29 offset:64
  v_mfma_f32_16x16x32_bf16 v[80:83], v[204:207], v[128:131], v[80:83]
  v_mfma_f32_16x16x32_bf16 v[84:87], v[204:207], v[132:135], v[84:87]
  ds_read_b64_tr_b16 v[190:191], v29 offset:576
  v_mfma_f32_16x16x32_bf16 v[88:91], v[204:207], v[136:139], v[88:91]
  v_mfma_f32_16x16x32_bf16 v[92:95], v[204:207], v[140:143], v[92:95]
  s_waitcnt lgkmcnt(0)
  s_waitcnt vmcnt(8)
  ds_read_b64_tr_b16 v[192:193], v28 offset:4096
  v_mfma_f32_16x16x32_bf16 v[32:35], v[176:179], v[144:147], v[32:35]
  v_mfma_f32_16x16x32_bf16 v[36:39], v[176:179], v[148:151], v[36:39]
  ds_read_b64_tr_b16 v[194:195], v28 offset:4608
  v_mfma_f32_16x16x32_bf16 v[40:43], v[176:179], v[152:155], v[40:43]
  v_mfma_f32_16x16x32_bf16 v[44:47], v[176:179], v[156:159], v[44:47]
  ds_read_b64_tr_b16 v[196:197], v29 offset:4096
  v_mfma_f32_16x16x32_bf16 v[48:51], v[180:183], v[144:147], v[48:51]
  v_mfma_f32_16x16x32_bf16 v[52:55], v[180:183], v[148:151], v[52:55]
  ds_read_b64_tr_b16 v[198:199], v29 offset:4608
  v_mfma_f32_16x16x32_bf16 v[56:59], v[180:183], v[152:155], v[56:59]
  v_mfma_f32_16x16x32_bf16 v[60:63], v[180:183], v[156:159], v[60:63]
  ds_read_b64_tr_b16 v[200:201], v28 offset:4160
  v_mfma_f32_16x16x32_bf16 v[64:67], v[184:187], v[144:147], v[64:67]
  v_mfma_f32_16x16x32_bf16 v[68:71], v[184:187], v[148:151], v[68:71]
  ds_read_b64_tr_b16 v[202:203], v28 offset:4672
  v_mfma_f32_16x16x32_bf16 v[72:75], v[184:187], v[152:155], v[72:75]
  v_mfma_f32_16x16x32_bf16 v[76:79], v[184:187], v[156:159], v[76:79]
  ds_read_b64_tr_b16 v[204:205], v29 offset:4160
  v_mfma_f32_16x16x32_bf16 v[80:83], v[188:191], v[144:147], v[80:83]
  v_mfma_f32_16x16x32_bf16 v[84:87], v[188:191], v[148:151], v[84:87]
  ds_read_b64_tr_b16 v[206:207], v29 offset:4672
  v_mfma_f32_16x16x32_bf16 v[88:91], v[188:191], v[152:155], v[88:91]
  v_mfma_f32_16x16x32_bf16 v[92:95], v[188:191], v[156:159], v[92:95]
  s_waitcnt lgkmcnt(0)
  s_waitcnt vmcnt(0)
  ds_read_b64_tr_b16 v[176:177], v28 offset:8192
  v_mfma_f32_16x16x32_bf16 v[32:35], v[192:195], v[160:163], v[32:35]
  v_mfma_f32_16x16x32_bf16 v[36:39], v[192:195], v[164:167], v[36:39]
  ds_read_b64_tr_b16 v[178:179], v28 offset:8704
  v_mfma_f32_16x16x32_bf16 v[40:43], v[192:195], v[168:171], v[40:43]
  v_mfma_f32_16x16x32_bf16 v[44:47], v[192:195], v[172:175], v[44:47]
  ds_read_b64_tr_b16 v[180:181], v29 offset:8192
  v_mfma_f32_16x16x32_bf16 v[48:51], v[196:199], v[160:163], v[48:51]
  v_mfma_f32_16x16x32_bf16 v[52:55], v[196:199], v[164:167], v[52:55]
  ds_read_b64_tr_b16 v[182:183], v29 offset:8704
  v_mfma_f32_16x16x32_bf16 v[56:59], v[196:199], v[168:171], v[56:59]
  v_mfma_f32_16x16x32_bf16 v[60:63], v[196:199], v[172:175], v[60:63]
  ds_read_b64_tr_b16 v[184:185], v28 offset:8256
  v_mfma_f32_16x16x32_bf16 v[64:67], v[200:203], v[160:163], v[64:67]
  v_mfma_f32_16x16x32_bf16 v[68:71], v[200:203], v[164:167], v[68:71]
  ds_read_b64_tr_b16 v[186:187], v28 offset:8768
  v_mfma_f32_16x16x32_bf16 v[72:75], v[200:203], v[168:171], v[72:75]
  v_mfma_f32_16x16x32_bf16 v[76:79], v[200:203], v[172:175], v[76:79]
  ds_read_b64_tr_b16 v[188:189], v29 offset:8256
  v_mfma_f32_16x16x32_bf16 v[80:83], v[204:207], v[160:163], v[80:83]
  v_mfma_f32_16x16x32_bf16 v[84:87], v[204:207], v[164:167], v[84:87]
  ds_read_b64_tr_b16 v[190:191], v29 offset:8768
  v_mfma_f32_16x16x32_bf16 v[88:91], v[204:207], v[168:171], v[88:91]
  v_mfma_f32_16x16x32_bf16 v[92:95], v[204:207], v[172:175], v[92:95]
  s_waitcnt lgkmcnt(0)
  s_cmp_eq_u32 s5, 3
  s_cbranch_scc1 G2_SKIP
  v_mfma_f32_16x16x32_bf16 v[32:35], v[176:179], v[96:99], v[32:35]
  v_mfma_f32_16x16x32_bf16 v[36:39], v[176:179], v[100:103], v[36:39]
  v_mfma_f32_16x16x32_bf16 v[40:43], v[176:179], v[104:107], v[40:43]
  v_mfma_f32_16x16x32_bf16 v[44:47], v[176:179], v[108:111], v[44:47]
  v_mfma_f32_16x16x32_bf16 v[48:51], v[180:183], v[96:99], v[48:51]
  v_mfma_f32_16x16x32_bf16 v[52:55], v[180:183], v[100:103], v[52:55]
  v_mfma_f32_16x16x32_bf16 v[56:59], v[180:183], v[104:107], v[56:59]
  v_mfma_f32_16x16x32_bf16 v[60:63], v[180:183], v[108:111], v[60:63]
  v_mfma_f32_16x16x32_bf16 v[64:67], v[184:187], v[96:99], v[64:67]
  v_mfma_f32_16x16x32_bf16 v[68:71], v[184:187], v[100:103], v[68:71]
  v_mfma_f32_16x16x32_bf16 v[72:75], v[184:187], v[104:107], v[72:75]
  v_mfma_f32_16x16x32_bf16 v[76:79], v[184:187], v[108:111], v[76:79]
  v_mfma_f32_16x16x32_bf16 v[80:83], v[188:191], v[96:99], v[80:83]
  v_mfma_f32_16x16x32_bf16 v[84:87], v[188:191], v[100:103], v[84:87]
  v_mfma_f32_16x16x32_bf16 v[88:91], v[188:191], v[104:107], v[88:91]
  v_mfma_f32_16x16x32_bf16 v[92:95], v[188:191], v[108:111], v[92:95]
  s_waitcnt lgkmcnt(0)
G2_SKIP:
  s_nop 15
  ds_write_b128 v19, v[20:23] offset:0
  ds_write_b128 v19, v[24:27] offset:16
  v_mul_u32_u24 v5, 272, v3
  v_lshl_add_u32 v5, v4, 4, v5
  s_mul_i32 s38, s5, 17408
  s_add_u32 s38, s38, 9216
  v_add_u32 v5, s38, v5
  ds_write_b128 v5, v[32:35] offset:0
  ds_write_b128 v5, v[36:39] offset:4352
  ds_write_b128 v5, v[40:43] offset:8704
  ds_write_b128 v5, v[44:47] offset:13056
  ds_write_b128 v5, v[48:51] offset:64
  ds_write_b128 v5, v[52:55] offset:4416
  ds_write_b128 v5, v[56:59] offset:8768
  ds_write_b128 v5, v[60:63] offset:13120
  ds_write_b128 v5, v[64:67] offset:128
  ds_write_b128 v5, v[68:71] offset:4480
  ds_write_b128 v5, v[72:75] offset:8832
  ds_write_b128 v5, v[76:79] offset:13184
  ds_write_b128 v5, v[80:83] offset:192
  ds_write_b128 v5, v[84:87] offset:4544
  ds_write_b128 v5, v[88:91] offset:8896
  ds_write_b128 v5, v[92:95] offset:13248
  s_waitcnt lgkmcnt(0)
  s_barrier
  v_lshrrev_b32 v1, 3, v0
  v_and_b32 v2, 7, v0
  v_mul_u32_u24 v3, 272, v1
  v_lshl_add_u32 v3, v2, 5, v3
  v_add_u32 v3, 9216, v3
  v_add_u32 v7, 34816, v3
  v_mul_u32_u24 v4, 1152, v2
  v_lshl_add_u32 v4, v1, 1, v4
  v_add_u32 v5, s35, v1
  v_lshlrev_b32 v5, 10, v5
  v_lshl_add_u32 v5, v2, 4, v5
  s_lshl_b32 s38, s36, 1
  v_add_u32 v5, s38, v5
  v_add_u32 v6, 0, v5
  ds_read_b128 v[32:35], v3 offset:0
  ds_read_b128 v[36:39], v3 offset:16
  ds_read_b128 v[40:43], v3 offset:17408
  ds_read_b128 v[44:47], v3 offset:17424
  ds_read_b128 v[48:51], v7 offset:0
  ds_read_b128 v[52:55], v7 offset:16
  ds_read_b128 v[56:59], v7 offset:17408
  ds_read_b128 v[60:63], v7 offset:17424
  ds_read_u16 v64, v4 offset:0
  ds_read_u16 v65, v4 offset:144
  ds_read_u16 v66, v4 offset:288
  ds_read_u16 v67, v4 offset:432
  ds_read_u16 v68, v4 offset:576
  ds_read_u16 v69, v4 offset:720
  ds_read_u16 v70, v4 offset:864
  ds_read_u16 v71, v4 offset:1008
  s_waitcnt lgkmcnt(0)
  v_add_f32 v32, v32, v40
  v_add_f32 v48, v48, v56
  v_add_f32 v32, v32, v48
  v_lshlrev_b32 v64, 16, v64
  v_add_f32 v33, v33, v41
  v_add_f32 v49, v49, v57
  v_add_f32 v33, v33, v49
  v_lshlrev_b32 v65, 16, v65
  v_add_f32 v34, v34, v42
  v_add_f32 v50, v50, v58
  v_add_f32 v34, v34, v50
  v_lshlrev_b32 v66, 16, v66
  v_add_f32 v35, v35, v43
  v_add_f32 v51, v51, v59
  v_add_f32 v35, v35, v51
  v_lshlrev_b32 v67, 16, v67
  v_add_f32 v36, v36, v44
  v_add_f32 v52, v52, v60
  v_add_f32 v36, v36, v52
  v_lshlrev_b32 v68, 16, v68
  v_add_f32 v37, v37, v45
  v_add_f32 v53, v53, v61
  v_add_f32 v37, v37, v53
  v_lshlrev_b32 v69, 16, v69
  v_add_f32 v38, v38, v46
  v_add_f32 v54, v54, v62
  v_add_f32 v38, v38, v54
  v_lshlrev_b32 v70, 16, v70
  v_add_f32 v39, v39, v47
  v_add_f32 v55, v55, v63
  v_add_f32 v39, v39, v55
  v_lshlrev_b32 v71, 16, v71
  v_lshlrev_b32 v72, 16, v224
  v_and_b32 v73, 0xffff0000, v224
  v_lshlrev_b32 v80, 16, v228
  v_and_b32 v81, 0xffff0000, v228
  v_lshlrev_b32 v74, 16, v225
  v_and_b32 v75, 0xffff0000, v225
  v_lshlrev_b32 v82, 16, v229
  v_and_b32 v83, 0xffff0000, v229
  v_lshlrev_b32 v76, 16, v226
  v_and_b32 v77, 0xffff0000, v226
  v_lshlrev_b32 v84, 16, v230
  v_and_b32 v85, 0xffff0000, v230
  v_lshlrev_b32 v78, 16, v227
  v_and_b32 v79, 0xffff0000, v227
  v_lshlrev_b32 v86, 16, v231
  v_and_b32 v87, 0xffff0000, v231
  v_mul_f32 v80, v80, v64
  v_mul_f32 v81, v81, v65
  v_cvt_pk_bf16_f32 v88, v80, v81
  v_lshlrev_b32 v80, 16, v88
  v_and_b32 v81, 0xffff0000, v88
  v_add_f32 v72, v72, v80
  v_add_f32 v73, v73, v81
  v_cvt_pk_bf16_f32 v88, v72, v73
  v_lshlrev_b32 v72, 16, v88
  v_and_b32 v73, 0xffff0000, v88
  v_cvt_pk_bf16_f32 v88, v32, v33
  v_lshlrev_b32 v32, 16, v88
  v_and_b32 v33, 0xffff0000, v88
  v_add_f32 v72, v72, v32
  v_add_f32 v73, v73, v33
  v_cvt_pk_bf16_f32 v8, v72, v73
  v_mul_f32 v82, v82, v66
  v_mul_f32 v83, v83, v67
  v_cvt_pk_bf16_f32 v88, v82, v83
  v_lshlrev_b32 v82, 16, v88
  v_and_b32 v83, 0xffff0000, v88
  v_add_f32 v74, v74, v82
  v_add_f32 v75, v75, v83
  v_cvt_pk_bf16_f32 v88, v74, v75
  v_lshlrev_b32 v74, 16, v88
  v_and_b32 v75, 0xffff0000, v88
  v_cvt_pk_bf16_f32 v88, v34, v35
  v_lshlrev_b32 v34, 16, v88
  v_and_b32 v35, 0xffff0000, v88
  v_add_f32 v74, v74, v34
  v_add_f32 v75, v75, v35
  v_cvt_pk_bf16_f32 v9, v74, v75
  v_mul_f32 v84, v84, v68
  v_mul_f32 v85, v85, v69
  v_cvt_pk_bf16_f32 v88, v84, v85
  v_lshlrev_b32 v84, 16, v88
  v_and_b32 v85, 0xffff0000, v88
  v_add_f32 v76, v76, v84
  v_add_f32 v77, v77, v85
  v_cvt_pk_bf16_f32 v88, v76, v77
  v_lshlrev_b32 v76, 16, v88
  v_and_b32 v77, 0xffff0000, v88
  v_cvt_pk_bf16_f32 v88, v36, v37
  v_lshlrev_b32 v36, 16, v88
  v_and_b32 v37, 0xffff0000, v88
  v_add_f32 v76, v76, v36
  v_add_f32 v77, v77, v37
  v_cvt_pk_bf16_f32 v10, v76, v77
  v_mul_f32 v86, v86, v70
  v_mul_f32 v87, v87, v71
  v_cvt_pk_bf16_f32 v88, v86, v87
  v_lshlrev_b32 v86, 16, v88
  v_and_b32 v87, 0xffff0000, v88
  v_add_f32 v78, v78, v86
  v_add_f32 v79, v79, v87
  v_cvt_pk_bf16_f32 v88, v78, v79
  v_lshlrev_b32 v78, 16, v88
  v_and_b32 v79, 0xffff0000, v88
  v_cvt_pk_bf16_f32 v88, v38, v39
  v_lshlrev_b32 v38, 16, v88
  v_and_b32 v39, 0xffff0000, v88
  v_add_f32 v78, v78, v38
  v_add_f32 v79, v79, v39
  v_cvt_pk_bf16_f32 v11, v78, v79
  buffer_store_dwordx4 v[8:11], v6, s[28:31], 0 offen sc0 sc1
  s_nop 1
  v_add_u32 v6, 32768, v5
  ds_read_b128 v[32:35], v3 offset:8704
  ds_read_b128 v[36:39], v3 offset:8720
  ds_read_b128 v[40:43], v3 offset:26112
  ds_read_b128 v[44:47], v3 offset:26128
  ds_read_b128 v[48:51], v7 offset:8704
  ds_read_b128 v[52:55], v7 offset:8720
  ds_read_b128 v[56:59], v7 offset:26112
  ds_read_b128 v[60:63], v7 offset:26128
  ds_read_u16 v64, v4 offset:64
  ds_read_u16 v65, v4 offset:208
  ds_read_u16 v66, v4 offset:352
  ds_read_u16 v67, v4 offset:496
  ds_read_u16 v68, v4 offset:640
  ds_read_u16 v69, v4 offset:784
  ds_read_u16 v70, v4 offset:928
  ds_read_u16 v71, v4 offset:1072
  s_waitcnt lgkmcnt(0)
  v_add_f32 v32, v32, v40
  v_add_f32 v48, v48, v56
  v_add_f32 v32, v32, v48
  v_lshlrev_b32 v64, 16, v64
  v_add_f32 v33, v33, v41
  v_add_f32 v49, v49, v57
  v_add_f32 v33, v33, v49
  v_lshlrev_b32 v65, 16, v65
  v_add_f32 v34, v34, v42
  v_add_f32 v50, v50, v58
  v_add_f32 v34, v34, v50
  v_lshlrev_b32 v66, 16, v66
  v_add_f32 v35, v35, v43
  v_add_f32 v51, v51, v59
  v_add_f32 v35, v35, v51
  v_lshlrev_b32 v67, 16, v67
  v_add_f32 v36, v36, v44
  v_add_f32 v52, v52, v60
  v_add_f32 v36, v36, v52
  v_lshlrev_b32 v68, 16, v68
  v_add_f32 v37, v37, v45
  v_add_f32 v53, v53, v61
  v_add_f32 v37, v37, v53
  v_lshlrev_b32 v69, 16, v69
  v_add_f32 v38, v38, v46
  v_add_f32 v54, v54, v62
  v_add_f32 v38, v38, v54
  v_lshlrev_b32 v70, 16, v70
  v_add_f32 v39, v39, v47
  v_add_f32 v55, v55, v63
  v_add_f32 v39, v39, v55
  v_lshlrev_b32 v71, 16, v71
  v_lshlrev_b32 v72, 16, v232
  v_and_b32 v73, 0xffff0000, v232
  v_lshlrev_b32 v80, 16, v236
  v_and_b32 v81, 0xffff0000, v236
  v_lshlrev_b32 v74, 16, v233
  v_and_b32 v75, 0xffff0000, v233
  v_lshlrev_b32 v82, 16, v237
  v_and_b32 v83, 0xffff0000, v237
  v_lshlrev_b32 v76, 16, v234
  v_and_b32 v77, 0xffff0000, v234
  v_lshlrev_b32 v84, 16, v238
  v_and_b32 v85, 0xffff0000, v238
  v_lshlrev_b32 v78, 16, v235
  v_and_b32 v79, 0xffff0000, v235
  v_lshlrev_b32 v86, 16, v239
  v_and_b32 v87, 0xffff0000, v239
  v_mul_f32 v80, v80, v64
  v_mul_f32 v81, v81, v65
  v_cvt_pk_bf16_f32 v88, v80, v81
  v_lshlrev_b32 v80, 16, v88
  v_and_b32 v81, 0xffff0000, v88
  v_add_f32 v72, v72, v80
  v_add_f32 v73, v73, v81
  v_cvt_pk_bf16_f32 v88, v72, v73
  v_lshlrev_b32 v72, 16, v88
  v_and_b32 v73, 0xffff0000, v88
  v_cvt_pk_bf16_f32 v88, v32, v33
  v_lshlrev_b32 v32, 16, v88
  v_and_b32 v33, 0xffff0000, v88
  v_add_f32 v72, v72, v32
  v_add_f32 v73, v73, v33
  v_cvt_pk_bf16_f32 v8, v72, v73
  v_mul_f32 v82, v82, v66
  v_mul_f32 v83, v83, v67
  v_cvt_pk_bf16_f32 v88, v82, v83
  v_lshlrev_b32 v82, 16, v88
  v_and_b32 v83, 0xffff0000, v88
  v_add_f32 v74, v74, v82
  v_add_f32 v75, v75, v83
  v_cvt_pk_bf16_f32 v88, v74, v75
  v_lshlrev_b32 v74, 16, v88
  v_and_b32 v75, 0xffff0000, v88
  v_cvt_pk_bf16_f32 v88, v34, v35
  v_lshlrev_b32 v34, 16, v88
  v_and_b32 v35, 0xffff0000, v88
  v_add_f32 v74, v74, v34
  v_add_f32 v75, v75, v35
  v_cvt_pk_bf16_f32 v9, v74, v75
  v_mul_f32 v84, v84, v68
  v_mul_f32 v85, v85, v69
  v_cvt_pk_bf16_f32 v88, v84, v85
  v_lshlrev_b32 v84, 16, v88
  v_and_b32 v85, 0xffff0000, v88
  v_add_f32 v76, v76, v84
  v_add_f32 v77, v77, v85
  v_cvt_pk_bf16_f32 v88, v76, v77
  v_lshlrev_b32 v76, 16, v88
  v_and_b32 v77, 0xffff0000, v88
  v_cvt_pk_bf16_f32 v88, v36, v37
  v_lshlrev_b32 v36, 16, v88
  v_and_b32 v37, 0xffff0000, v88
  v_add_f32 v76, v76, v36
  v_add_f32 v77, v77, v37
  v_cvt_pk_bf16_f32 v10, v76, v77
  v_mul_f32 v86, v86, v70
  v_mul_f32 v87, v87, v71
  v_cvt_pk_bf16_f32 v88, v86, v87
  v_lshlrev_b32 v86, 16, v88
  v_and_b32 v87, 0xffff0000, v88
  v_add_f32 v78, v78, v86
  v_add_f32 v79, v79, v87
  v_cvt_pk_bf16_f32 v88, v78, v79
  v_lshlrev_b32 v78, 16, v88
  v_and_b32 v79, 0xffff0000, v88
  v_cvt_pk_bf16_f32 v88, v38, v39
  v_lshlrev_b32 v38, 16, v88
  v_and_b32 v39, 0xffff0000, v88
  v_add_f32 v78, v78, v38
  v_add_f32 v79, v79, v39
  v_cvt_pk_bf16_f32 v11, v78, v79
  buffer_store_dwordx4 v[8:11], v6, s[28:31], 0 offen sc0 sc1
  s_nop 1
G2_END:
  s_endpgm
.section .rodata,"a"
.p2align 6
.amdhsa_kernel prep_kernel
  .amdhsa_next_free_vgpr 72
  .amdhsa_next_free_sgpr 102
  .amdhsa_accum_offset 72
  .amdhsa_group_segment_fixed_size 0
  .amdhsa_kernarg_size 104
  .amdhsa_user_sgpr_count 2
  .amdhsa_user_sgpr_kernarg_segment_ptr 1
  .amdhsa_system_sgpr_workgroup_id_x 1
.end_amdhsa_kernel
.p2align 6
.amdhsa_kernel mid_kernel
  .amdhsa_next_free_vgpr 208
  .amdhsa_next_free_sgpr 102
  .amdhsa_accum_offset 208
  .amdhsa_group_segment_fixed_size 0
  .amdhsa_kernarg_size 104
  .amdhsa_user_sgpr_count 2
  .amdhsa_user_sgpr_kernarg_segment_ptr 1
  .amdhsa_system_sgpr_workgroup_id_x 1
.end_amdhsa_kernel
.p2align 6
.amdhsa_kernel gemm2_kernel
  .amdhsa_next_free_vgpr 240
  .amdhsa_next_free_sgpr 102
  .amdhsa_accum_offset 240
  .amdhsa_group_segment_fixed_size 0
  .amdhsa_kernarg_size 104
  .amdhsa_user_sgpr_count 2
  .amdhsa_user_sgpr_kernarg_segment_ptr 1
  .amdhsa_system_sgpr_workgroup_id_x 1
.end_amdhsa_kernel
```
